```python
import torch

def _softmax(x, axis=-1):
    return torch.softmax(x, dim=axis)
def _gelu(x):
    return torch.nn.functional.gelu(x, approximate="tanh")
def _silu(x):
    return torch.nn.functional.silu(x)
def _sigmoid(x):
    return torch.sigmoid(x)
def _layernorm(x, axis=-1, eps=1e-5):
    m = x.mean(dim=axis, keepdim=True)
    v = x.var(dim=axis, keepdim=True, unbiased=False)
    return (x - m) / torch.sqrt(v + eps)
def _scatter_add(tgt, idx, src, axis=0):
    return tgt.clone().index_add_(axis, idx, src)
def _segment_sum(src, seg, n):
    out = torch.zeros((n,) + src.shape[1:], dtype=src.dtype)
    return out.index_add_(0, seg, src)
def _pad(x, pw):
    flat = tuple(v for pair in reversed(pw) for v in pair)
    return torch.nn.functional.pad(x, flat)

kernel_name = 'concat_heads__sliding_local_dilated__linear_attn_block__prompt'

def setup_inputs():

    _w = (lambda a: (lambda t: t.to(torch.bfloat16) if t.is_floating_point() else t)(torch.as_tensor(a)))
    def _A_setup():
        B, S, D = 1, 2048, 640
        return {
            "x": _w((lambda *s: torch.randn(*s, dtype=torch.bfloat16) * 0.2)(B, S, D)),
            "wqkv": _w((lambda *s: torch.randn(*s, dtype=torch.bfloat16) * 0.2)(D, 3 * D)),
            "wo": _w((lambda *s: torch.randn(*s, dtype=torch.bfloat16) * 0.05)(D, D)),
        }
    _A_in = _A_setup()

    def _B_setup():
        B, S, D = 1, 2048, 640
        return {
            "x": _w((lambda *s: torch.randn(*s, dtype=torch.bfloat16) * 0.05)(B, S, D)),
            "wqkv": _w((lambda *s: torch.randn(*s, dtype=torch.bfloat16) * 1.6)(D, 3 * D)),
            "wo": _w((lambda *s: torch.randn(*s, dtype=torch.bfloat16) * 0.8)(D, D)),
        }
    _B_in = _B_setup()

    return {
        "A_x": _A_in["x"],
        "A_wqkv": _A_in["wqkv"],
        "A_wo": _A_in["wo"],
        "B_x": _B_in["x"],
        "B_wqkv": _B_in["wqkv"],
        "B_wo": _B_in["wo"],
    }

def reference(A_x, A_wqkv, A_wo, B_x, B_wqkv, B_wo):
    def _A_ref(x, wqkv, wo):
        B, S, D = x.shape
        H = 32; Dh = D // H
        W, dil = 8, 2
        qkv = (lambda x, *d: x.permute(*d))((x @ wqkv).reshape(B, S, 3, H, Dh), 2, 0, 3, 1, 4)
        q, k, v = qkv[0], qkv[1], qkv[2]
        scale = Dh ** -0.5
        pos = torch.arange(S)
        off = torch.arange(W) * dil
        idx = pos[:, None] - off[None, :]
        mask = idx >= 0
        idx_c = torch.where(mask, idx, 0).reshape(-1)
        kg = k[:, :, idx_c, :].reshape(B, H, S, W, Dh)
        vg = v[:, :, idx_c, :].reshape(B, H, S, W, Dh)
        logits = torch.einsum("bhsd,bhswd->bhsw", q, kg) * scale
        logits = torch.where(mask[None, None, :, :], logits, -1e9)
        attn = _softmax(logits, axis=-1)
        o = torch.einsum("bhsw,bhswd->bhsd", attn, vg)
        return (lambda x, *d: x.permute(*d))(o, 0, 2, 1, 3).reshape(B, S, D) @ wo

    def _B_ref(x, wqkv, wo):
        B, S, D = x.shape
        H = 32; Dh = D // H
        qkv = (lambda x, *d: x.permute(*d))((x @ wqkv).reshape(B, S, 3, H, Dh), 2, 0, 3, 1, 4)
        q, k, v = qkv[0], qkv[1], qkv[2]
        phi = lambda t: torch.where(t > 0, t + 1, torch.exp(t)) + 1e-6
        pq, pk = phi(q), phi(k)
        kv = torch.einsum("bhsd,bhse->bhde", pk, v)
        z = torch.einsum("bhsd->bhd", pk)
        num = torch.einsum("bhqd,bhde->bhqe", pq, kv)
        den = torch.einsum("bhqd,bhd->bhq", pq, z)[..., None] + 1e-6
        o = num / den
        return (lambda x, *d: x.permute(*d))(o, 0, 2, 1, 3).reshape(B, S, D) @ wo

    a = _A_ref(A_x, A_wqkv, A_wo)
    b = _B_ref(B_x, B_wqkv, B_wo)
    return torch.concatenate([a, b], axis=-1)
```

```asm
; @launch grid=(256,1,1) block=(256,1,1) lds=163840
.amdgcn_target "amdgcn-amd-amdhsa--gfx950"
.text
.globl concat_heads__sliding_local_dilated__linear_attn_block__prompt_kernel
.p2align 8
.type concat_heads__sliding_local_dilated__linear_attn_block__prompt_kernel,@function
concat_heads__sliding_local_dilated__linear_attn_block__prompt_kernel:
  s_cmp_ge_u32 s2, 256
  s_cbranch_scc1 L_end
  s_bfe_u32 s28, s2, 0x10002
  s_xor_b32 s28, s28, 1
  s_mul_i32 s5, s28, 24
  s_add_u32 s6, s0, s5
  s_addc_u32 s7, s1, 0
  s_load_dwordx2 s[8:9], s[6:7], 0
  s_load_dwordx2 s[12:13], s[6:7], 8
  s_load_dwordx2 s[16:17], s[6:7], 16
  s_load_dwordx2 s[20:21], s[0:1], 48
  s_load_dwordx2 s[40:41], s[0:1], 56
  s_load_dwordx2 s[24:25], s[0:1], 64
  s_getpc_b64 s[86:87]
L_pc0:
  s_bfe_u32 s30, s2, 0x30003
  s_lshl_b32 s3, s30, 12
  v_lshlrev_b32 v6, 4, v0
  v_add_u32 v6, s3, v6
  v_min_u32 v6, L_end-L_pc0-16, v6
  global_load_dwordx4 v[60:63], v6, s[86:87]
  v_and_b32 v1, 63, v0
  v_lshrrev_b32 v2, 6, v0
  s_and_b32 s3, s2, 3
  v_readfirstlane_b32 s31, v2
  s_lshl_b32 s3, s3, 2
  s_lshr_b32 s78, s2, 6
  s_add_u32 s29, s3, s78
  s_add_u32 s3, s30, s78
  s_lshl_b32 s3, s3, 2
  s_mov_b32 s84, 0x21043210
  s_mov_b32 s85, 0x04321043
  s_lshr_b64 s[84:85], s[84:85], s3
  v_bfe_u32 v4, v0, 4, 2
  v_lshrrev_b32 v6, 3, v1
  v_mul_u32_u24 v6, 2560, v6
  v_and_b32 v7, 7, v1
  v_and_b32 v23, 1, v4
  v_xor_b32 v7, v7, v23
  v_lshl_add_u32 v40, v7, 4, v6
  v_add_u32 v41, 256, v40
  v_xor_b32 v7, 4, v7
  v_lshl_add_u32 v42, v7, 4, v6
  v_add_u32 v42, 18432, v42
  v_add_u32 v43, 256, v42
  s_lshl_b32 s3, s29, 7
  s_lshl_b32 s4, s31, 5
  s_add_u32 s48, s3, s4
  s_mul_i32 s32, s48, 1280
  s_and_b32 s3, s84, 7
  s_lshl_b32 s58, s3, 8
  s_add_u32 s58, s58, s32
  s_mul_i32 s79, s31, 12288
  s_add_u32 s79, s79, 102720
  s_mov_b32 m0, s79
  s_mov_b32 s10, 2621440
  s_mov_b32 s11, 0x00020000
  s_mov_b32 s14, 2457600
  s_mov_b32 s15, 0x00020000
  v_mul_u32_u24 v24, 6554, v1
  v_lshlrev_b32 v46, 4, v1
  v_add_u32 v25, 1280, v46
  s_movk_i32 s4, 1120
  s_movk_i32 s5, 1280
  v_lshrrev_b32 v52, 16, v24
  v_lshrrev_b32 v7, 17, v24
  v_mad_u32_u24 v8, v52, s4, v25
  v_mad_u32_u24 v8, v7, s5, v8
  v_add_u32 v6, 419456, v24
  v_lshrrev_b32 v53, 16, v6
  v_lshrrev_b32 v7, 17, v6
  v_mad_u32_u24 v9, v53, s4, v25
  v_mad_u32_u24 v9, v7, s5, v9
  v_add_u32 v6, 838912, v24
  v_lshrrev_b32 v54, 16, v6
  v_lshrrev_b32 v7, 17, v6
  v_mad_u32_u24 v10, v54, s4, v25
  v_mad_u32_u24 v10, v7, s5, v10
  v_add_u32 v6, 1258368, v24
  v_lshrrev_b32 v55, 16, v6
  v_lshrrev_b32 v7, 17, v6
  v_mad_u32_u24 v11, v55, s4, v25
  v_mad_u32_u24 v11, v7, s5, v11
  v_add_u32 v6, 1677824, v24
  v_lshrrev_b32 v56, 16, v6
  v_lshrrev_b32 v7, 17, v6
  v_mad_u32_u24 v12, v56, s4, v25
  v_mad_u32_u24 v12, v7, s5, v12
  v_add_u32 v12, 4096, v12
  s_mul_i32 s4, s30, 160
  s_mul_i32 s5, s31, 61440
  s_add_u32 s34, s5, s4
  s_mul_i32 s68, s3, 491520
  s_add_u32 s68, s68, s34
  s_add_u32 s5, s31, 1
  s_lshr_b32 s5, s5, 1
  s_lshl_b32 s5, s5, 5
  s_mul_i32 s45, s31, 5120
  s_add_u32 s36, s5, s45
  s_waitcnt lgkmcnt(0)
  buffer_load_dwordx4 v40, s[8:11], s58 offen offset:0 lds
  buffer_load_dwordx4 v41, s[8:11], s58 offen offset:1024 lds
  buffer_load_dwordx4 v42, s[8:11], s58 offen offset:2048 lds
  buffer_load_dwordx4 v43, s[8:11], s58 offen offset:3072 lds
  s_mov_b32 m0, s36
  s_nop 0
  buffer_load_dwordx4 v8, s[12:15], s68 offen offset:0 lds
  buffer_load_dwordx4 v9, s[12:15], s68 offen offset:1024 lds
  buffer_load_dwordx4 v10, s[12:15], s68 offen offset:2048 lds
  buffer_load_dwordx4 v11, s[12:15], s68 offen offset:3072 lds
  s_add_u32 m0, s36, 4096
  s_nop 0
  buffer_load_dwordx4 v12, s[12:15], s68 offen offset:0 lds
  s_mov_b32 s18, 819200
  s_mov_b32 s19, 0x00020000
  s_mov_b32 s22, 5242880
  s_mov_b32 s23, 0x00020000
  s_mov_b32 s26, 16777216
  s_mov_b32 s27, 0x00020000
  s_mov_b32 s42, 256
  s_mov_b32 s43, 0x00020000
  s_or_b32 s3, s2, s31
  s_cmp_lg_u32 s3, 0
  s_cbranch_scc1 L_notag
  s_memrealtime s[4:5]
  s_waitcnt lgkmcnt(0)
  s_lshl_b32 s4, s4, 6
  s_or_b32 s4, s4, 1
  v_mov_b32 v6, s4
  v_mov_b32 v7, 0
  s_mov_b64 exec, 1
  buffer_store_dword v6, v7, s[40:43], 0 offen sc1
  s_mov_b64 exec, -1
L_notag:
  s_add_u32 s59, s58, 128
  s_add_u32 s69, s68, 245760
  s_bfe_u32 s3, s84, 0x30004
  s_lshl_b32 s60, s3, 8
  s_add_u32 s60, s60, s32
  s_add_u32 s61, s60, 128
  s_mul_i32 s70, s3, 491520
  s_add_u32 s70, s70, s34
  s_add_u32 s71, s70, 245760
  s_bfe_u32 s3, s84, 0x30008
  s_lshl_b32 s62, s3, 8
  s_add_u32 s62, s62, s32
  s_add_u32 s63, s62, 128
  s_mul_i32 s72, s3, 491520
  s_add_u32 s72, s72, s34
  s_add_u32 s73, s72, 245760
  s_bfe_u32 s3, s84, 0x3000c
  s_lshl_b32 s64, s3, 8
  s_add_u32 s64, s64, s32
  s_add_u32 s65, s64, 128
  s_mul_i32 s74, s3, 491520
  s_add_u32 s74, s74, s34
  s_add_u32 s75, s74, 245760
  s_bfe_u32 s3, s84, 0x30010
  s_lshl_b32 s66, s3, 8
  s_add_u32 s66, s66, s32
  s_add_u32 s67, s66, 128
  s_mul_i32 s76, s3, 491520
  s_add_u32 s76, s76, s34
  s_add_u32 s77, s76, 245760
  v_and_b32 v3, 15, v0
  v_bfe_u32 v49, v0, 2, 2
  v_and_b32 v50, 3, v0
  v_mul_u32_u24 v6, 320, v49
  v_mul_u32_u24 v7, 5120, v4
  v_add_u32 v6, v6, v7
  v_add_u32 v7, 1, v4
  v_lshrrev_b32 v7, 1, v7
  v_lshl_add_u32 v6, v7, 5, v6
  v_mul_u32_u24 v7, 40, v50
  v_add_u32 v26, v6, v7
  v_add_u32 v27, 61632, v26
  s_cmp_eq_u32 s28, 0
  s_cselect_b32 s3, 40, 8
  s_cselect_b32 s4, 8, 40
  v_mad_u32_u24 v184, v50, s3, v6
  v_add_u32 v186, s4, v184
  v_add_u32 v188, s4, v186
  v_add_u32 v190, s4, v188
  v_add_u32 v192, 32, v26
  v_add_u32 v185, 61632, v184
  v_add_u32 v187, 61632, v186
  v_add_u32 v189, 61632, v188
  v_add_u32 v191, 61632, v190
  v_add_u32 v193, 61632, v192
  v_lshrrev_b32 v6, 3, v3
  v_lshlrev_b32 v6, 4, v6
  v_and_b32 v7, 7, v3
  v_add_u32 v6, v6, v7
  v_lshlrev_b32 v6, 7, v6
  v_lshrrev_b32 v7, 1, v3
  v_and_b32 v7, 5, v7
  v_lshlrev_b32 v23, 1, v4
  v_xor_b32 v7, v7, v23
  v_lshl_add_u32 v6, v7, 4, v6
  v_add_u32 v44, s79, v6
  v_xor_b32 v45, 16, v44
  s_lshl_b32 s54, s30, 13
  s_lshl_b32 s3, s31, 11
  s_add_u32 s54, s54, s3
  s_add_u32 s54, s54, 6291456
  s_lshl_b32 s55, s30, 7
  s_lshl_b32 s3, s31, 2
  s_add_u32 s55, s55, s3
  s_add_u32 s55, s55, 7380992
  s_xor_b32 s3, s28, 1
  s_or_b32 s56, s3, s29
  v_lshlrev_b32 v51, 2, v1
  s_cmp_lg_u32 s56, 0
  s_nop 0
  s_cbranch_scc1 L_nozero
  v_mov_b32 v64, 0
  v_mov_b32 v65, 0
  v_mov_b32 v66, 0
  v_mov_b32 v67, 0
  buffer_store_dwordx4 v[64:67], v46, s[24:27], s54 offen offset:0 sc1
  buffer_store_dwordx4 v[64:67], v46, s[24:27], s54 offen offset:1024 sc1
  s_nop 1
L_nozero:
  s_movk_i32 s4, 1120
  s_mov_b32 s5, 245600
  s_mov_b32 s6, 487680
  v_mad_u32_u24 v18, v52, s4, v46
  v_mad_u32_u24 v13, v52, s5, v46
  v_lshrrev_b32 v7, 1, v52
  v_mul_u32_u24 v7, s6, v7
  v_sub_u32 v13, v13, v7
  v_mad_u32_u24 v19, v53, s4, v46
  v_mad_u32_u24 v14, v53, s5, v46
  v_lshrrev_b32 v7, 1, v53
  v_mul_u32_u24 v7, s6, v7
  v_sub_u32 v14, v14, v7
  v_mad_u32_u24 v20, v54, s4, v46
  v_mad_u32_u24 v15, v54, s5, v46
  v_lshrrev_b32 v7, 1, v54
  v_mul_u32_u24 v7, s6, v7
  v_sub_u32 v15, v15, v7
  v_mad_u32_u24 v21, v55, s4, v46
  v_mad_u32_u24 v16, v55, s5, v46
  v_lshrrev_b32 v7, 1, v55
  v_mul_u32_u24 v7, s6, v7
  v_sub_u32 v16, v16, v7
  v_mad_u32_u24 v22, v56, s4, v46
  v_mad_u32_u24 v17, v56, s5, v46
  v_lshrrev_b32 v7, 1, v56
  v_mul_u32_u24 v7, s6, v7
  v_sub_u32 v17, v17, v7
  v_add_u32 v17, 4096, v17
  v_add_u32 v22, 4096, v22
  s_mul_i32 s5, s31, 40960
  s_mul_i32 s4, s30, 160
  s_add_u32 s35, s5, s4
  s_lshr_b32 s3, s2, 3
  s_lshl_b32 s3, s3, 2
  s_add_u32 s3, s3, s31
  v_mul_u32_u24 v7, 10, v52
  v_sub_u32 v7, v1, v7
  v_lshlrev_b32 v7, 7, v7
  v_lshl_add_u32 v6, v52, 7, s3
  v_mul_u32_u24 v35, 1280, v6
  v_add_u32 v35, v35, v7
  s_add_u32 s3, s30, 4
  s_lshl_b32 s3, s3, 2
  s_mov_b32 s6, 0x21043210
  s_mov_b32 s7, 0x04321043
  s_lshr_b64 s[6:7], s[6:7], s3
  s_and_b32 s3, s6, 7
  s_lshl_b32 s3, s3, 2
  s_add_u32 s3, s3, s78
  s_lshl_b32 s3, s3, 2
  s_add_u32 s3, s3, s31
  s_mul_i32 s3, s3, 30720
  s_add_u32 s3, s3, s4
  s_add_u32 s3, s3, 1280
  v_lshrrev_b32 v6, 2, v1
  v_mul_u32_u24 v6, 3840, v6
  v_bfe_u32 v7, v1, 1, 1
  v_mul_u32_u24 v7, 1280, v7
  v_and_b32 v23, 1, v1
  v_mul_u32_u24 v23, 156, v23
  v_add3_u32 v6, v6, v7, v23
  v_add_u32 v58, s3, v6
  v_mul_u32_u24 v6, 160, v49
  v_mul_u32_u24 v7, 40, v50
  v_add_u32 v6, v6, v7
  v_mul_u32_u24 v7, 3200, v4
  v_add_u32 v28, v6, v7
  v_add_u32 v29, 51200, v28
  v_lshrrev_b32 v7, 1, v4
  v_mul_u32_u24 v7, 12800, v7
  v_add_u32 v6, v6, v7
  v_and_b32 v7, 1, v4
  v_mul_u32_u24 v7, 3200, v7
  v_add_u32 v30, v6, v7
  v_add_u32 v31, 51200, v30
  s_and_b32 s3, s30, 1
  s_mul_i32 s3, s3, 5120
  s_add_u32 s3, s3, 1024
  v_and_b32 v6, 1, v4
  v_mul_u32_u24 v6, 2560, v6
  v_lshl_add_u32 v6, v3, 4, v6
  v_lshrrev_b32 v7, 1, v4
  v_lshl_add_u32 v6, v7, 3, v6
  v_add_u32 v47, s3, v6
  v_mul_u32_u24 v6, 5120, v3
  v_mul_u32_u24 v7, 40, v4
  v_add_u32 v48, v6, v7
  s_lshl_b32 s3, s31, 5
  s_add_u32 s3, s3, 102720
  v_mul_u32_u24 v6, 5768, v49
  v_mul_u32_u24 v7, 288, v50
  v_add_u32 v6, v6, v7
  v_lshl_add_u32 v6, v4, 3, v6
  v_add_u32 v37, s3, v6
  v_add_u32 v37, 16, v37
  v_mul_u32_u24 v23, 5768, v4
  v_mul_u32_u24 v6, 288, v49
  v_add_u32 v6, v6, v23
  v_lshl_add_u32 v6, v50, 3, v6
  v_add_u32 v38, s3, v6
  v_add_u32 v6, v7, v23
  v_lshl_add_u32 v6, v49, 3, v6
  v_add_u32 v39, s3, v6
  v_add_u32 v39, 23072, v39
  s_lshl_b32 s3, s28, 4
  s_add_u32 s3, s3, s29
  s_lshl_b32 s3, s3, 2
  s_add_u32 s3, s3, s31
  s_mul_i32 s44, s48, 2560
  s_mul_i32 s4, s28, 1280
  s_add_u32 s44, s44, s4
  s_lshl_b32 s49, s3, 7
  s_add_u32 s49, s49, 7340032
  s_lshr_b32 s33, s3, 2
  s_lshl_b32 s33, s33, 7
  s_add_u32 s33, s33, 7389184
  s_getreg_b32 s38, hwreg(HW_REG_XCC_ID, 0, 4)
  s_lshl_b32 s38, s38, 1
  s_mul_i32 s4, s30, 10240
  v_lshrrev_b32 v6, 3, v1
  v_mul_u32_u24 v6, 1536, v6
  v_lshl_add_u32 v6, v1, 7, v6
  v_add_u32 v252, s4, v6
  s_lshr_b32 s3, s30, 1
  s_mul_i32 s3, s3, 20480
  s_and_b32 s5, s30, 1
  s_mul_i32 s5, s5, 5120
  s_add_u32 s5, s5, s3
  s_add_u32 s5, s5, 1024
  v_and_b32 v6, 4, v1
  v_mul_u32_u24 v6, 2560, v6
  v_and_b32 v7, 2, v1
  v_mul_u32_u24 v7, 1280, v7
  v_add3_u32 v6, v6, v7, s5
  v_and_b32 v7, 1, v1
  v_lshl_add_u32 v6, v7, 7, v6
  v_cmp_gt_u32 vcc, 32, v1
  s_nop 1
  v_cndmask_b32 v252, v6, v252, vcc
  s_lshl_b32 s3, s29, 3
  s_add_u32 s3, s3, s30
  s_lshl_b32 s4, s3, 7
  s_add_u32 s4, s4, 7356416
  s_mul_i32 s50, s3, 5120
  s_add_u32 s50, s50, 5242880
  s_lshl_b32 s5, s30, 8
  s_lshl_b32 s6, s31, 6
  s_add_u32 s5, s5, s6
  s_add_u32 s5, s5, 7372800
  s_lshl_b32 s6, s29, 2
  s_add_u32 s6, s6, s5
  s_sub_u32 s3, s4, 1024
  s_cmp_eq_u32 s28, 0
  s_cselect_b32 s47, s4, s6
  s_cselect_b32 s57, s3, s5
  v_lshlrev_b32 v25, 2, v3
  v_mul_u32_u24 v25, s28, v25
  s_cmp_eq_u32 s31, 3
  s_cselect_b32 s51, 1, 0
  s_or_b32 s51, s51, s28
  s_cmp_eq_u32 s31, 0
  s_cselect_b32 s81, 1, 0
  s_cmp_lg_u32 s29, 0
  s_cselect_b32 s81, s81, 0
  s_or_b32 s81, s81, s28
  s_mov_b32 s52, 0x3fb8aa3b
  s_mov_b32 s53, 0x358637bd
  s_mov_b32 s82, s52
  s_mov_b32 s83, s52
  s_mov_b32 s86, s53
  s_mov_b32 s87, s53
  s_add_u32 m0, s79, 4096
  s_nop 0
  buffer_load_dwordx4 v40, s[8:11], s59 offen offset:0 lds
  buffer_load_dwordx4 v41, s[8:11], s59 offen offset:1024 lds
  buffer_load_dwordx4 v42, s[8:11], s59 offen offset:2048 lds
  buffer_load_dwordx4 v43, s[8:11], s59 offen offset:3072 lds
  s_add_u32 m0, s36, 20544
  s_nop 0
  buffer_load_dwordx4 v8, s[12:15], s69 offen offset:0 lds
  buffer_load_dwordx4 v9, s[12:15], s69 offen offset:1024 lds
  buffer_load_dwordx4 v10, s[12:15], s69 offen offset:2048 lds
  buffer_load_dwordx4 v11, s[12:15], s69 offen offset:3072 lds
  s_add_u32 m0, s36, 24640
  s_nop 0
  buffer_load_dwordx4 v12, s[12:15], s69 offen offset:0 lds
  s_add_u32 m0, s79, 8192
  s_waitcnt vmcnt(9)
  ds_read_b128 a[0:3], v44 offset:0
  ds_read_b128 a[4:7], v44 offset:1024
  ds_read_b128 a[8:11], v45 offset:0
  ds_read_b128 a[12:15], v45 offset:1024
  s_barrier
  ds_read_b64_tr_b16 a[160:161], v184 offset:0
  ds_read_b64_tr_b16 a[162:163], v184 offset:1280
  ds_read_b64_tr_b16 a[164:165], v186 offset:0
  ds_read_b64_tr_b16 a[166:167], v186 offset:1280
  ds_read_b64_tr_b16 a[168:169], v188 offset:0
  ds_read_b64_tr_b16 a[170:171], v188 offset:1280
  ds_read_b64_tr_b16 a[172:173], v190 offset:0
  ds_read_b64_tr_b16 a[174:175], v190 offset:1280
  ds_read_b64_tr_b16 a[176:177], v192 offset:0
  ds_read_b64_tr_b16 a[178:179], v192 offset:1280
  ds_read_b64_tr_b16 a[180:181], v184 offset:160
  ds_read_b64_tr_b16 a[182:183], v184 offset:1440
  s_waitcnt lgkmcnt(10)
  v_mfma_f32_16x16x32_bf16 v[64:67], a[0:3], a[160:163], 0
  ds_read_b64_tr_b16 a[184:185], v186 offset:160
  v_mfma_f32_16x16x32_bf16 v[68:71], a[4:7], a[160:163], 0
  ds_read_b64_tr_b16 a[186:187], v186 offset:1440
  buffer_load_dwordx4 v40, s[8:11], s60 offen offset:0 lds
  s_waitcnt lgkmcnt(10)
  v_mfma_f32_16x16x32_bf16 v[72:75], a[0:3], a[164:167], 0
  ds_read_b64_tr_b16 a[188:189], v188 offset:160
  v_mfma_f32_16x16x32_bf16 v[76:79], a[4:7], a[164:167], 0
  ds_read_b64_tr_b16 a[190:191], v188 offset:1440
  buffer_load_dwordx4 v41, s[8:11], s60 offen offset:1024 lds
  s_waitcnt lgkmcnt(10)
  v_mfma_f32_16x16x32_bf16 v[80:83], a[0:3], a[168:171], 0
  ds_read_b64_tr_b16 a[160:161], v190 offset:160
  v_mfma_f32_16x16x32_bf16 v[84:87], a[4:7], a[168:171], 0
  ds_read_b64_tr_b16 a[162:163], v190 offset:1440
  buffer_load_dwordx4 v42, s[8:11], s60 offen offset:2048 lds
  s_waitcnt lgkmcnt(10)
  v_mfma_f32_16x16x32_bf16 v[88:91], a[0:3], a[172:175], 0
  ds_read_b64_tr_b16 a[164:165], v192 offset:160
  v_mfma_f32_16x16x32_bf16 v[92:95], a[4:7], a[172:175], 0
  ds_read_b64_tr_b16 a[166:167], v192 offset:1440
  buffer_load_dwordx4 v43, s[8:11], s60 offen offset:3072 lds
  s_add_u32 m0, s36, 41088
  s_waitcnt lgkmcnt(10)
  v_mfma_f32_16x16x32_bf16 v[96:99], a[0:3], a[176:179], 0
  ds_read_b64_tr_b16 a[168:169], v184 offset:2560
  v_mfma_f32_16x16x32_bf16 v[100:103], a[4:7], a[176:179], 0
  ds_read_b64_tr_b16 a[170:171], v184 offset:3840
  buffer_load_dwordx4 v8, s[12:15], s70 offen offset:0 lds
  s_waitcnt lgkmcnt(10)
  v_mfma_f32_16x16x32_bf16 v[104:107], a[0:3], a[180:183], 0
  ds_read_b64_tr_b16 a[172:173], v186 offset:2560
  v_mfma_f32_16x16x32_bf16 v[108:111], a[4:7], a[180:183], 0
  ds_read_b64_tr_b16 a[174:175], v186 offset:3840
  buffer_load_dwordx4 v9, s[12:15], s70 offen offset:1024 lds
  s_waitcnt lgkmcnt(10)
  v_mfma_f32_16x16x32_bf16 v[112:115], a[0:3], a[184:187], 0
  ds_read_b64_tr_b16 a[176:177], v188 offset:2560
  v_mfma_f32_16x16x32_bf16 v[116:119], a[4:7], a[184:187], 0
  ds_read_b64_tr_b16 a[178:179], v188 offset:3840
  buffer_load_dwordx4 v10, s[12:15], s70 offen offset:2048 lds
  s_waitcnt lgkmcnt(10)
  v_mfma_f32_16x16x32_bf16 v[120:123], a[0:3], a[188:191], 0
  ds_read_b64_tr_b16 a[180:181], v190 offset:2560
  v_mfma_f32_16x16x32_bf16 v[124:127], a[4:7], a[188:191], 0
  ds_read_b64_tr_b16 a[182:183], v190 offset:3840
  buffer_load_dwordx4 v11, s[12:15], s70 offen offset:3072 lds
  s_add_u32 m0, s36, 45184
  s_waitcnt lgkmcnt(10)
  v_mfma_f32_16x16x32_bf16 v[128:131], a[0:3], a[160:163], 0
  ds_read_b64_tr_b16 a[184:185], v192 offset:2560
  v_mfma_f32_16x16x32_bf16 v[132:135], a[4:7], a[160:163], 0
  ds_read_b64_tr_b16 a[186:187], v192 offset:3840
  buffer_load_dwordx4 v12, s[12:15], s70 offen offset:0 lds
  s_add_u32 m0, s36, 61632
  s_waitcnt lgkmcnt(10)
  v_mfma_f32_16x16x32_bf16 v[136:139], a[0:3], a[164:167], 0
  ds_read_b64_tr_b16 a[188:189], v184 offset:2720
  v_mfma_f32_16x16x32_bf16 v[140:143], a[4:7], a[164:167], 0
  ds_read_b64_tr_b16 a[190:191], v184 offset:4000
  buffer_load_dwordx4 v8, s[12:15], s71 offen offset:0 lds
  s_waitcnt lgkmcnt(10)
  v_mfma_f32_16x16x32_bf16 v[64:67], a[8:11], a[168:171], v[64:67]
  ds_read_b64_tr_b16 a[160:161], v186 offset:2720
  v_mfma_f32_16x16x32_bf16 v[68:71], a[12:15], a[168:171], v[68:71]
  ds_read_b64_tr_b16 a[162:163], v186 offset:4000
  buffer_load_dwordx4 v9, s[12:15], s71 offen offset:1024 lds
  s_waitcnt lgkmcnt(10)
  v_mfma_f32_16x16x32_bf16 v[72:75], a[8:11], a[172:175], v[72:75]
  ds_read_b64_tr_b16 a[164:165], v188 offset:2720
  v_mfma_f32_16x16x32_bf16 v[76:79], a[12:15], a[172:175], v[76:79]
  ds_read_b64_tr_b16 a[166:167], v188 offset:4000
  buffer_load_dwordx4 v10, s[12:15], s71 offen offset:2048 lds
  s_waitcnt lgkmcnt(10)
  v_mfma_f32_16x16x32_bf16 v[80:83], a[8:11], a[176:179], v[80:83]
  ds_read_b64_tr_b16 a[168:169], v190 offset:2720
  v_mfma_f32_16x16x32_bf16 v[84:87], a[12:15], a[176:179], v[84:87]
  ds_read_b64_tr_b16 a[170:171], v190 offset:4000
  buffer_load_dwordx4 v11, s[12:15], s71 offen offset:3072 lds
  s_add_u32 m0, s36, 65728
  s_waitcnt lgkmcnt(10)
  v_mfma_f32_16x16x32_bf16 v[88:91], a[8:11], a[180:183], v[88:91]
  ds_read_b64_tr_b16 a[172:173], v192 offset:2720
  v_mfma_f32_16x16x32_bf16 v[92:95], a[12:15], a[180:183], v[92:95]
  ds_read_b64_tr_b16 a[174:175], v192 offset:4000
  buffer_load_dwordx4 v12, s[12:15], s71 offen offset:0 lds
  s_add_u32 m0, s36, 82176
  s_waitcnt vmcnt(14)
  s_barrier
  ds_read_b128 a[16:19], v44 offset:4096
  ds_read_b128 a[20:23], v44 offset:5120
  ds_read_b128 a[24:27], v45 offset:4096
  ds_read_b128 a[28:31], v45 offset:5120
  s_waitcnt lgkmcnt(14)
  v_mfma_f32_16x16x32_bf16 v[96:99], a[8:11], a[184:187], v[96:99]
  ds_read_b64_tr_b16 a[176:177], v184 offset:20544
  v_mfma_f32_16x16x32_bf16 v[100:103], a[12:15], a[184:187], v[100:103]
  ds_read_b64_tr_b16 a[178:179], v184 offset:21824
  buffer_load_dwordx4 v8, s[12:15], s72 offen offset:0 lds
  s_waitcnt lgkmcnt(14)
  v_mfma_f32_16x16x32_bf16 v[104:107], a[8:11], a[188:191], v[104:107]
  ds_read_b64_tr_b16 a[180:181], v186 offset:20544
  v_mfma_f32_16x16x32_bf16 v[108:111], a[12:15], a[188:191], v[108:111]
  ds_read_b64_tr_b16 a[182:183], v186 offset:21824
  buffer_load_dwordx4 v9, s[12:15], s72 offen offset:1024 lds
  s_waitcnt lgkmcnt(14)
  v_mfma_f32_16x16x32_bf16 v[112:115], a[8:11], a[160:163], v[112:115]
  ds_read_b64_tr_b16 a[184:185], v188 offset:20544
  v_mfma_f32_16x16x32_bf16 v[116:119], a[12:15], a[160:163], v[116:119]
  ds_read_b64_tr_b16 a[186:187], v188 offset:21824
  buffer_load_dwordx4 v10, s[12:15], s72 offen offset:2048 lds
  s_waitcnt lgkmcnt(14)
  v_mfma_f32_16x16x32_bf16 v[120:123], a[8:11], a[164:167], v[120:123]
  ds_read_b64_tr_b16 a[188:189], v190 offset:20544
  v_mfma_f32_16x16x32_bf16 v[124:127], a[12:15], a[164:167], v[124:127]
  ds_read_b64_tr_b16 a[190:191], v190 offset:21824
  buffer_load_dwordx4 v11, s[12:15], s72 offen offset:3072 lds
  s_add_u32 m0, s36, 86272
  s_waitcnt lgkmcnt(14)
  v_mfma_f32_16x16x32_bf16 v[128:131], a[8:11], a[168:171], v[128:131]
  ds_read_b64_tr_b16 a[160:161], v192 offset:20544
  v_mfma_f32_16x16x32_bf16 v[132:135], a[12:15], a[168:171], v[132:135]
  ds_read_b64_tr_b16 a[162:163], v192 offset:21824
  buffer_load_dwordx4 v12, s[12:15], s72 offen offset:0 lds
  s_mov_b32 m0, s79
  s_waitcnt lgkmcnt(14)
  v_mfma_f32_16x16x32_bf16 v[136:139], a[8:11], a[172:175], v[136:139]
  ds_read_b64_tr_b16 a[164:165], v184 offset:20704
  v_mfma_f32_16x16x32_bf16 v[140:143], a[12:15], a[172:175], v[140:143]
  ds_read_b64_tr_b16 a[166:167], v184 offset:21984
  s_waitcnt lgkmcnt(10)
  v_mfma_f32_16x16x32_bf16 v[64:67], a[16:19], a[176:179], v[64:67]
  ds_read_b64_tr_b16 a[168:169], v186 offset:20704
  v_mfma_f32_16x16x32_bf16 v[68:71], a[20:23], a[176:179], v[68:71]
  ds_read_b64_tr_b16 a[170:171], v186 offset:21984
  buffer_load_dwordx4 v40, s[8:11], s61 offen offset:0 lds
  s_waitcnt lgkmcnt(10)
  v_mfma_f32_16x16x32_bf16 v[72:75], a[16:19], a[180:183], v[72:75]
  ds_read_b64_tr_b16 a[172:173], v188 offset:20704
  v_mfma_f32_16x16x32_bf16 v[76:79], a[20:23], a[180:183], v[76:79]
  ds_read_b64_tr_b16 a[174:175], v188 offset:21984
  s_waitcnt lgkmcnt(10)
  v_mfma_f32_16x16x32_bf16 v[80:83], a[16:19], a[184:187], v[80:83]
  ds_read_b64_tr_b16 a[176:177], v190 offset:20704
  v_mfma_f32_16x16x32_bf16 v[84:87], a[20:23], a[184:187], v[84:87]
  ds_read_b64_tr_b16 a[178:179], v190 offset:21984
  buffer_load_dwordx4 v41, s[8:11], s61 offen offset:1024 lds
  s_waitcnt lgkmcnt(10)
  v_mfma_f32_16x16x32_bf16 v[88:91], a[16:19], a[188:191], v[88:91]
  ds_read_b64_tr_b16 a[180:181], v192 offset:20704
  v_mfma_f32_16x16x32_bf16 v[92:95], a[20:23], a[188:191], v[92:95]
  ds_read_b64_tr_b16 a[182:183], v192 offset:21984
  s_waitcnt lgkmcnt(10)
  v_mfma_f32_16x16x32_bf16 v[96:99], a[16:19], a[160:163], v[96:99]
  ds_read_b64_tr_b16 a[184:185], v184 offset:23104
  v_mfma_f32_16x16x32_bf16 v[100:103], a[20:23], a[160:163], v[100:103]
  ds_read_b64_tr_b16 a[186:187], v184 offset:24384
  buffer_load_dwordx4 v42, s[8:11], s61 offen offset:2048 lds
  s_waitcnt lgkmcnt(10)
  v_mfma_f32_16x16x32_bf16 v[104:107], a[16:19], a[164:167], v[104:107]
  ds_read_b64_tr_b16 a[188:189], v186 offset:23104
  v_mfma_f32_16x16x32_bf16 v[108:111], a[20:23], a[164:167], v[108:111]
  ds_read_b64_tr_b16 a[190:191], v186 offset:24384
  s_waitcnt lgkmcnt(10)
  v_mfma_f32_16x16x32_bf16 v[112:115], a[16:19], a[168:171], v[112:115]
  ds_read_b64_tr_b16 a[160:161], v188 offset:23104
  v_mfma_f32_16x16x32_bf16 v[116:119], a[20:23], a[168:171], v[116:119]
  ds_read_b64_tr_b16 a[162:163], v188 offset:24384
  buffer_load_dwordx4 v43, s[8:11], s61 offen offset:3072 lds
  s_add_u32 m0, s79, 4096
  s_waitcnt lgkmcnt(10)
  v_mfma_f32_16x16x32_bf16 v[120:123], a[16:19], a[172:175], v[120:123]
  ds_read_b64_tr_b16 a[164:165], v190 offset:23104
  v_mfma_f32_16x16x32_bf16 v[124:127], a[20:23], a[172:175], v[124:127]
  ds_read_b64_tr_b16 a[166:167], v190 offset:24384
  s_waitcnt lgkmcnt(10)
  v_mfma_f32_16x16x32_bf16 v[128:131], a[16:19], a[176:179], v[128:131]
  ds_read_b64_tr_b16 a[168:169], v192 offset:23104
  v_mfma_f32_16x16x32_bf16 v[132:135], a[20:23], a[176:179], v[132:135]
  ds_read_b64_tr_b16 a[170:171], v192 offset:24384
  buffer_load_dwordx4 v40, s[8:11], s62 offen offset:0 lds
  s_waitcnt lgkmcnt(10)
  v_mfma_f32_16x16x32_bf16 v[136:139], a[16:19], a[180:183], v[136:139]
  ds_read_b64_tr_b16 a[172:173], v184 offset:23264
  v_mfma_f32_16x16x32_bf16 v[140:143], a[20:23], a[180:183], v[140:143]
  ds_read_b64_tr_b16 a[174:175], v184 offset:24544
  s_waitcnt lgkmcnt(10)
  v_mfma_f32_16x16x32_bf16 v[64:67], a[24:27], a[184:187], v[64:67]
  ds_read_b64_tr_b16 a[176:177], v186 offset:23264
  v_mfma_f32_16x16x32_bf16 v[68:71], a[28:31], a[184:187], v[68:71]
  ds_read_b64_tr_b16 a[178:179], v186 offset:24544
  buffer_load_dwordx4 v41, s[8:11], s62 offen offset:1024 lds
  s_waitcnt lgkmcnt(10)
  v_mfma_f32_16x16x32_bf16 v[72:75], a[24:27], a[188:191], v[72:75]
  ds_read_b64_tr_b16 a[180:181], v188 offset:23264
  v_mfma_f32_16x16x32_bf16 v[76:79], a[28:31], a[188:191], v[76:79]
  ds_read_b64_tr_b16 a[182:183], v188 offset:24544
  s_waitcnt lgkmcnt(10)
  v_mfma_f32_16x16x32_bf16 v[80:83], a[24:27], a[160:163], v[80:83]
  ds_read_b64_tr_b16 a[184:185], v190 offset:23264
  v_mfma_f32_16x16x32_bf16 v[84:87], a[28:31], a[160:163], v[84:87]
  ds_read_b64_tr_b16 a[186:187], v190 offset:24544
  buffer_load_dwordx4 v42, s[8:11], s62 offen offset:2048 lds
  s_waitcnt lgkmcnt(10)
  v_mfma_f32_16x16x32_bf16 v[88:91], a[24:27], a[164:167], v[88:91]
  ds_read_b64_tr_b16 a[188:189], v192 offset:23264
  v_mfma_f32_16x16x32_bf16 v[92:95], a[28:31], a[164:167], v[92:95]
  ds_read_b64_tr_b16 a[190:191], v192 offset:24544
  s_waitcnt vmcnt(17)
  s_barrier
  ds_read_b128 a[32:35], v44 offset:8192
  ds_read_b128 a[36:39], v44 offset:9216
  ds_read_b128 a[40:43], v45 offset:8192
  ds_read_b128 a[44:47], v45 offset:9216
  v_mov_b32 v7, 0
  buffer_load_dword v36, v7, s[40:43], 0 offen sc1
  s_waitcnt lgkmcnt(14)
  v_mfma_f32_16x16x32_bf16 v[96:99], a[24:27], a[168:171], v[96:99]
  ds_read_b64_tr_b16 a[160:161], v184 offset:41088
  v_mfma_f32_16x16x32_bf16 v[100:103], a[28:31], a[168:171], v[100:103]
  ds_read_b64_tr_b16 a[162:163], v184 offset:42368
  buffer_load_dwordx4 v43, s[8:11], s62 offen offset:3072 lds
  s_mov_b32 m0, s36
  s_waitcnt lgkmcnt(14)
  v_mfma_f32_16x16x32_bf16 v[104:107], a[24:27], a[172:175], v[104:107]
  ds_read_b64_tr_b16 a[164:165], v186 offset:41088
  v_mfma_f32_16x16x32_bf16 v[108:111], a[28:31], a[172:175], v[108:111]
  ds_read_b64_tr_b16 a[166:167], v186 offset:42368
  s_waitcnt lgkmcnt(14)
  v_mfma_f32_16x16x32_bf16 v[112:115], a[24:27], a[176:179], v[112:115]
  ds_read_b64_tr_b16 a[168:169], v188 offset:41088
  v_mfma_f32_16x16x32_bf16 v[116:119], a[28:31], a[176:179], v[116:119]
  ds_read_b64_tr_b16 a[170:171], v188 offset:42368
  buffer_load_dwordx4 v8, s[12:15], s73 offen offset:0 lds
  s_waitcnt lgkmcnt(14)
  v_mfma_f32_16x16x32_bf16 v[120:123], a[24:27], a[180:183], v[120:123]
  ds_read_b64_tr_b16 a[172:173], v190 offset:41088
  v_mfma_f32_16x16x32_bf16 v[124:127], a[28:31], a[180:183], v[124:127]
  ds_read_b64_tr_b16 a[174:175], v190 offset:42368
  s_waitcnt lgkmcnt(14)
  v_mfma_f32_16x16x32_bf16 v[128:131], a[24:27], a[184:187], v[128:131]
  ds_read_b64_tr_b16 a[176:177], v192 offset:41088
  v_mfma_f32_16x16x32_bf16 v[132:135], a[28:31], a[184:187], v[132:135]
  ds_read_b64_tr_b16 a[178:179], v192 offset:42368
  buffer_load_dwordx4 v9, s[12:15], s73 offen offset:1024 lds
  s_waitcnt lgkmcnt(14)
  v_mfma_f32_16x16x32_bf16 v[136:139], a[24:27], a[188:191], v[136:139]
  ds_read_b64_tr_b16 a[180:181], v184 offset:41248
  v_mfma_f32_16x16x32_bf16 v[140:143], a[28:31], a[188:191], v[140:143]
  ds_read_b64_tr_b16 a[182:183], v184 offset:42528
  s_waitcnt lgkmcnt(10)
  v_mfma_f32_16x16x32_bf16 v[64:67], a[32:35], a[160:163], v[64:67]
  ds_read_b64_tr_b16 a[184:185], v186 offset:41248
  v_mfma_f32_16x16x32_bf16 v[68:71], a[36:39], a[160:163], v[68:71]
  ds_read_b64_tr_b16 a[186:187], v186 offset:42528
  buffer_load_dwordx4 v10, s[12:15], s73 offen offset:2048 lds
  s_waitcnt lgkmcnt(10)
  v_mfma_f32_16x16x32_bf16 v[72:75], a[32:35], a[164:167], v[72:75]
  ds_read_b64_tr_b16 a[188:189], v188 offset:41248
  v_mfma_f32_16x16x32_bf16 v[76:79], a[36:39], a[164:167], v[76:79]
  ds_read_b64_tr_b16 a[190:191], v188 offset:42528
  s_waitcnt lgkmcnt(10)
  v_mfma_f32_16x16x32_bf16 v[80:83], a[32:35], a[168:171], v[80:83]
  ds_read_b64_tr_b16 a[160:161], v190 offset:41248
  v_mfma_f32_16x16x32_bf16 v[84:87], a[36:39], a[168:171], v[84:87]
  ds_read_b64_tr_b16 a[162:163], v190 offset:42528
  buffer_load_dwordx4 v11, s[12:15], s73 offen offset:3072 lds
  s_add_u32 m0, s36, 4096
  s_waitcnt lgkmcnt(10)
  v_mfma_f32_16x16x32_bf16 v[88:91], a[32:35], a[172:175], v[88:91]
  ds_read_b64_tr_b16 a[164:165], v192 offset:41248
  v_mfma_f32_16x16x32_bf16 v[92:95], a[36:39], a[172:175], v[92:95]
  ds_read_b64_tr_b16 a[166:167], v192 offset:42528
  s_waitcnt lgkmcnt(10)
  v_mfma_f32_16x16x32_bf16 v[96:99], a[32:35], a[176:179], v[96:99]
  ds_read_b64_tr_b16 a[168:169], v184 offset:43648
  v_mfma_f32_16x16x32_bf16 v[100:103], a[36:39], a[176:179], v[100:103]
  ds_read_b64_tr_b16 a[170:171], v184 offset:44928
  buffer_load_dwordx4 v12, s[12:15], s73 offen offset:0 lds
  s_add_u32 m0, s79, 8192
  s_waitcnt lgkmcnt(10)
  v_mfma_f32_16x16x32_bf16 v[104:107], a[32:35], a[180:183], v[104:107]
  ds_read_b64_tr_b16 a[172:173], v186 offset:43648
  v_mfma_f32_16x16x32_bf16 v[108:111], a[36:39], a[180:183], v[108:111]
  ds_read_b64_tr_b16 a[174:175], v186 offset:44928
  s_waitcnt lgkmcnt(10)
  v_mfma_f32_16x16x32_bf16 v[112:115], a[32:35], a[184:187], v[112:115]
  ds_read_b64_tr_b16 a[176:177], v188 offset:43648
  v_mfma_f32_16x16x32_bf16 v[116:119], a[36:39], a[184:187], v[116:119]
  ds_read_b64_tr_b16 a[178:179], v188 offset:44928
  buffer_load_dwordx4 v40, s[8:11], s63 offen offset:0 lds
  s_waitcnt lgkmcnt(10)
  v_mfma_f32_16x16x32_bf16 v[120:123], a[32:35], a[188:191], v[120:123]
  ds_read_b64_tr_b16 a[180:181], v190 offset:43648
  v_mfma_f32_16x16x32_bf16 v[124:127], a[36:39], a[188:191], v[124:127]
  ds_read_b64_tr_b16 a[182:183], v190 offset:44928
  s_waitcnt lgkmcnt(10)
  v_mfma_f32_16x16x32_bf16 v[128:131], a[32:35], a[160:163], v[128:131]
  ds_read_b64_tr_b16 a[184:185], v192 offset:43648
  v_mfma_f32_16x16x32_bf16 v[132:135], a[36:39], a[160:163], v[132:135]
  ds_read_b64_tr_b16 a[186:187], v192 offset:44928
  buffer_load_dwordx4 v41, s[8:11], s63 offen offset:1024 lds
  s_waitcnt lgkmcnt(10)
  v_mfma_f32_16x16x32_bf16 v[136:139], a[32:35], a[164:167], v[136:139]
  ds_read_b64_tr_b16 a[188:189], v184 offset:43808
  v_mfma_f32_16x16x32_bf16 v[140:143], a[36:39], a[164:167], v[140:143]
  ds_read_b64_tr_b16 a[190:191], v184 offset:45088
  s_waitcnt lgkmcnt(10)
  v_mfma_f32_16x16x32_bf16 v[64:67], a[40:43], a[168:171], v[64:67]
  ds_read_b64_tr_b16 a[160:161], v186 offset:43808
  v_mfma_f32_16x16x32_bf16 v[68:71], a[44:47], a[168:171], v[68:71]
  ds_read_b64_tr_b16 a[162:163], v186 offset:45088
  buffer_load_dwordx4 v42, s[8:11], s63 offen offset:2048 lds
  s_waitcnt lgkmcnt(10)
  v_mfma_f32_16x16x32_bf16 v[72:75], a[40:43], a[172:175], v[72:75]
  ds_read_b64_tr_b16 a[164:165], v188 offset:43808
  v_mfma_f32_16x16x32_bf16 v[76:79], a[44:47], a[172:175], v[76:79]
  ds_read_b64_tr_b16 a[166:167], v188 offset:45088
  s_waitcnt lgkmcnt(10)
  v_mfma_f32_16x16x32_bf16 v[80:83], a[40:43], a[176:179], v[80:83]
  ds_read_b64_tr_b16 a[168:169], v190 offset:43808
  v_mfma_f32_16x16x32_bf16 v[84:87], a[44:47], a[176:179], v[84:87]
  ds_read_b64_tr_b16 a[170:171], v190 offset:45088
  buffer_load_dwordx4 v43, s[8:11], s63 offen offset:3072 lds
  s_waitcnt lgkmcnt(10)
  v_mfma_f32_16x16x32_bf16 v[88:91], a[40:43], a[180:183], v[88:91]
  ds_read_b64_tr_b16 a[172:173], v192 offset:43808
  v_mfma_f32_16x16x32_bf16 v[92:95], a[44:47], a[180:183], v[92:95]
  ds_read_b64_tr_b16 a[174:175], v192 offset:45088
  s_waitcnt vmcnt(23)
  s_waitcnt vmcnt(14)
  s_barrier
  ds_read_b128 a[48:51], v44 offset:0
  ds_read_b128 a[52:55], v44 offset:1024
  ds_read_b128 a[56:59], v45 offset:0
  ds_read_b128 a[60:63], v45 offset:1024
  s_add_u32 m0, s36, 20544
  s_waitcnt lgkmcnt(14)
  v_mfma_f32_16x16x32_bf16 v[96:99], a[40:43], a[184:187], v[96:99]
  ds_read_b64_tr_b16 a[176:177], v185 offset:0
  v_mfma_f32_16x16x32_bf16 v[100:103], a[44:47], a[184:187], v[100:103]
  ds_read_b64_tr_b16 a[178:179], v185 offset:1280
  buffer_load_dwordx4 v8, s[12:15], s74 offen offset:0 lds
  s_waitcnt lgkmcnt(14)
  v_mfma_f32_16x16x32_bf16 v[104:107], a[40:43], a[188:191], v[104:107]
  ds_read_b64_tr_b16 a[180:181], v187 offset:0
  v_mfma_f32_16x16x32_bf16 v[108:111], a[44:47], a[188:191], v[108:111]
  ds_read_b64_tr_b16 a[182:183], v187 offset:1280
  s_waitcnt lgkmcnt(14)
  v_mfma_f32_16x16x32_bf16 v[112:115], a[40:43], a[160:163], v[112:115]
  ds_read_b64_tr_b16 a[184:185], v189 offset:0
  v_mfma_f32_16x16x32_bf16 v[116:119], a[44:47], a[160:163], v[116:119]
  ds_read_b64_tr_b16 a[186:187], v189 offset:1280
  buffer_load_dwordx4 v9, s[12:15], s74 offen offset:1024 lds
  s_waitcnt lgkmcnt(14)
  v_mfma_f32_16x16x32_bf16 v[120:123], a[40:43], a[164:167], v[120:123]
  ds_read_b64_tr_b16 a[188:189], v191 offset:0
  v_mfma_f32_16x16x32_bf16 v[124:127], a[44:47], a[164:167], v[124:127]
  ds_read_b64_tr_b16 a[190:191], v191 offset:1280
  s_waitcnt lgkmcnt(14)
  v_mfma_f32_16x16x32_bf16 v[128:131], a[40:43], a[168:171], v[128:131]
  ds_read_b64_tr_b16 a[160:161], v193 offset:0
  v_mfma_f32_16x16x32_bf16 v[132:135], a[44:47], a[168:171], v[132:135]
  ds_read_b64_tr_b16 a[162:163], v193 offset:1280
  buffer_load_dwordx4 v10, s[12:15], s74 offen offset:2048 lds
  s_waitcnt lgkmcnt(14)
  v_mfma_f32_16x16x32_bf16 v[136:139], a[40:43], a[172:175], v[136:139]
  ds_read_b64_tr_b16 a[164:165], v185 offset:160
  v_mfma_f32_16x16x32_bf16 v[140:143], a[44:47], a[172:175], v[140:143]
  ds_read_b64_tr_b16 a[166:167], v185 offset:1440
  s_waitcnt lgkmcnt(10)
  v_mfma_f32_16x16x32_bf16 v[64:67], a[48:51], a[176:179], v[64:67]
  ds_read_b64_tr_b16 a[168:169], v187 offset:160
  v_mfma_f32_16x16x32_bf16 v[68:71], a[52:55], a[176:179], v[68:71]
  ds_read_b64_tr_b16 a[170:171], v187 offset:1440
  buffer_load_dwordx4 v11, s[12:15], s74 offen offset:3072 lds
  s_add_u32 m0, s36, 24640
  s_waitcnt lgkmcnt(10)
  v_mfma_f32_16x16x32_bf16 v[72:75], a[48:51], a[180:183], v[72:75]
  ds_read_b64_tr_b16 a[172:173], v189 offset:160
  v_mfma_f32_16x16x32_bf16 v[76:79], a[52:55], a[180:183], v[76:79]
  ds_read_b64_tr_b16 a[174:175], v189 offset:1440
  s_waitcnt lgkmcnt(10)
  v_mfma_f32_16x16x32_bf16 v[80:83], a[48:51], a[184:187], v[80:83]
  ds_read_b64_tr_b16 a[176:177], v191 offset:160
  v_mfma_f32_16x16x32_bf16 v[84:87], a[52:55], a[184:187], v[84:87]
  ds_read_b64_tr_b16 a[178:179], v191 offset:1440
  buffer_load_dwordx4 v12, s[12:15], s74 offen offset:0 lds
  s_mov_b32 m0, s79
  s_waitcnt lgkmcnt(10)
  v_mfma_f32_16x16x32_bf16 v[88:91], a[48:51], a[188:191], v[88:91]
  ds_read_b64_tr_b16 a[180:181], v193 offset:160
  v_mfma_f32_16x16x32_bf16 v[92:95], a[52:55], a[188:191], v[92:95]
  ds_read_b64_tr_b16 a[182:183], v193 offset:1440
  s_waitcnt lgkmcnt(10)
  v_mfma_f32_16x16x32_bf16 v[96:99], a[48:51], a[160:163], v[96:99]
  ds_read_b64_tr_b16 a[184:185], v185 offset:2560
  v_mfma_f32_16x16x32_bf16 v[100:103], a[52:55], a[160:163], v[100:103]
  ds_read_b64_tr_b16 a[186:187], v185 offset:3840
  buffer_load_dwordx4 v40, s[8:11], s64 offen offset:0 lds
  s_waitcnt lgkmcnt(10)
  v_mfma_f32_16x16x32_bf16 v[104:107], a[48:51], a[164:167], v[104:107]
  ds_read_b64_tr_b16 a[188:189], v187 offset:2560
  v_mfma_f32_16x16x32_bf16 v[108:111], a[52:55], a[164:167], v[108:111]
  ds_read_b64_tr_b16 a[190:191], v187 offset:3840
  s_waitcnt lgkmcnt(10)
  v_mfma_f32_16x16x32_bf16 v[112:115], a[48:51], a[168:171], v[112:115]
  ds_read_b64_tr_b16 a[160:161], v189 offset:2560
  v_mfma_f32_16x16x32_bf16 v[116:119], a[52:55], a[168:171], v[116:119]
  ds_read_b64_tr_b16 a[162:163], v189 offset:3840
  buffer_load_dwordx4 v41, s[8:11], s64 offen offset:1024 lds
  s_waitcnt lgkmcnt(10)
  v_mfma_f32_16x16x32_bf16 v[120:123], a[48:51], a[172:175], v[120:123]
  ds_read_b64_tr_b16 a[164:165], v191 offset:2560
  v_mfma_f32_16x16x32_bf16 v[124:127], a[52:55], a[172:175], v[124:127]
  ds_read_b64_tr_b16 a[166:167], v191 offset:3840
  s_waitcnt lgkmcnt(10)
  v_mfma_f32_16x16x32_bf16 v[128:131], a[48:51], a[176:179], v[128:131]
  ds_read_b64_tr_b16 a[168:169], v193 offset:2560
  v_mfma_f32_16x16x32_bf16 v[132:135], a[52:55], a[176:179], v[132:135]
  ds_read_b64_tr_b16 a[170:171], v193 offset:3840
  buffer_load_dwordx4 v42, s[8:11], s64 offen offset:2048 lds
  s_waitcnt lgkmcnt(10)
  v_mfma_f32_16x16x32_bf16 v[136:139], a[48:51], a[180:183], v[136:139]
  ds_read_b64_tr_b16 a[172:173], v185 offset:2720
  v_mfma_f32_16x16x32_bf16 v[140:143], a[52:55], a[180:183], v[140:143]
  ds_read_b64_tr_b16 a[174:175], v185 offset:4000
  s_waitcnt lgkmcnt(10)
  v_mfma_f32_16x16x32_bf16 v[64:67], a[56:59], a[184:187], v[64:67]
  ds_read_b64_tr_b16 a[176:177], v187 offset:2720
  v_mfma_f32_16x16x32_bf16 v[68:71], a[60:63], a[184:187], v[68:71]
  ds_read_b64_tr_b16 a[178:179], v187 offset:4000
  buffer_load_dwordx4 v43, s[8:11], s64 offen offset:3072 lds
  s_waitcnt lgkmcnt(10)
  v_mfma_f32_16x16x32_bf16 v[72:75], a[56:59], a[188:191], v[72:75]
  ds_read_b64_tr_b16 a[180:181], v189 offset:2720
  v_mfma_f32_16x16x32_bf16 v[76:79], a[60:63], a[188:191], v[76:79]
  ds_read_b64_tr_b16 a[182:183], v189 offset:4000
  s_waitcnt lgkmcnt(10)
  v_mfma_f32_16x16x32_bf16 v[80:83], a[56:59], a[160:163], v[80:83]
  ds_read_b64_tr_b16 a[184:185], v191 offset:2720
  v_mfma_f32_16x16x32_bf16 v[84:87], a[60:63], a[160:163], v[84:87]
  ds_read_b64_tr_b16 a[186:187], v191 offset:4000
  s_waitcnt lgkmcnt(10)
  v_mfma_f32_16x16x32_bf16 v[88:91], a[56:59], a[164:167], v[88:91]
  ds_read_b64_tr_b16 a[188:189], v193 offset:2720
  v_mfma_f32_16x16x32_bf16 v[92:95], a[60:63], a[164:167], v[92:95]
  ds_read_b64_tr_b16 a[190:191], v193 offset:4000
  s_waitcnt vmcnt(18)
  s_barrier
  ds_read_b128 a[64:67], v44 offset:4096
  ds_read_b128 a[68:71], v44 offset:5120
  ds_read_b128 a[72:75], v45 offset:4096
  ds_read_b128 a[76:79], v45 offset:5120
  s_add_u32 m0, s36, 41088
  s_waitcnt lgkmcnt(14)
  v_mfma_f32_16x16x32_bf16 v[96:99], a[56:59], a[168:171], v[96:99]
  ds_read_b64_tr_b16 a[160:161], v185 offset:20544
  v_mfma_f32_16x16x32_bf16 v[100:103], a[60:63], a[168:171], v[100:103]
  ds_read_b64_tr_b16 a[162:163], v185 offset:21824
  buffer_load_dwordx4 v8, s[12:15], s75 offen offset:0 lds
  s_waitcnt lgkmcnt(14)
  v_mfma_f32_16x16x32_bf16 v[104:107], a[56:59], a[172:175], v[104:107]
  ds_read_b64_tr_b16 a[164:165], v187 offset:20544
  v_mfma_f32_16x16x32_bf16 v[108:111], a[60:63], a[172:175], v[108:111]
  ds_read_b64_tr_b16 a[166:167], v187 offset:21824
  s_waitcnt lgkmcnt(14)
  v_mfma_f32_16x16x32_bf16 v[112:115], a[56:59], a[176:179], v[112:115]
  ds_read_b64_tr_b16 a[168:169], v189 offset:20544
  v_mfma_f32_16x16x32_bf16 v[116:119], a[60:63], a[176:179], v[116:119]
  ds_read_b64_tr_b16 a[170:171], v189 offset:21824
  buffer_load_dwordx4 v9, s[12:15], s75 offen offset:1024 lds
  s_waitcnt lgkmcnt(14)
  v_mfma_f32_16x16x32_bf16 v[120:123], a[56:59], a[180:183], v[120:123]
  ds_read_b64_tr_b16 a[172:173], v191 offset:20544
  v_mfma_f32_16x16x32_bf16 v[124:127], a[60:63], a[180:183], v[124:127]
  ds_read_b64_tr_b16 a[174:175], v191 offset:21824
  s_waitcnt lgkmcnt(14)
  v_mfma_f32_16x16x32_bf16 v[128:131], a[56:59], a[184:187], v[128:131]
  ds_read_b64_tr_b16 a[176:177], v193 offset:20544
  v_mfma_f32_16x16x32_bf16 v[132:135], a[60:63], a[184:187], v[132:135]
  ds_read_b64_tr_b16 a[178:179], v193 offset:21824
  buffer_load_dwordx4 v10, s[12:15], s75 offen offset:2048 lds
  s_waitcnt lgkmcnt(14)
  v_mfma_f32_16x16x32_bf16 v[136:139], a[56:59], a[188:191], v[136:139]
  ds_read_b64_tr_b16 a[180:181], v185 offset:20704
  v_mfma_f32_16x16x32_bf16 v[140:143], a[60:63], a[188:191], v[140:143]
  ds_read_b64_tr_b16 a[182:183], v185 offset:21984
  s_waitcnt lgkmcnt(10)
  v_mfma_f32_16x16x32_bf16 v[64:67], a[64:67], a[160:163], v[64:67]
  ds_read_b64_tr_b16 a[184:185], v187 offset:20704
  v_mfma_f32_16x16x32_bf16 v[68:71], a[68:71], a[160:163], v[68:71]
  ds_read_b64_tr_b16 a[186:187], v187 offset:21984
  buffer_load_dwordx4 v11, s[12:15], s75 offen offset:3072 lds
  s_add_u32 m0, s36, 45184
  s_waitcnt lgkmcnt(10)
  v_mfma_f32_16x16x32_bf16 v[72:75], a[64:67], a[164:167], v[72:75]
  ds_read_b64_tr_b16 a[188:189], v189 offset:20704
  v_mfma_f32_16x16x32_bf16 v[76:79], a[68:71], a[164:167], v[76:79]
  ds_read_b64_tr_b16 a[190:191], v189 offset:21984
  s_waitcnt lgkmcnt(10)
  v_mfma_f32_16x16x32_bf16 v[80:83], a[64:67], a[168:171], v[80:83]
  ds_read_b64_tr_b16 a[160:161], v191 offset:20704
  v_mfma_f32_16x16x32_bf16 v[84:87], a[68:71], a[168:171], v[84:87]
  ds_read_b64_tr_b16 a[162:163], v191 offset:21984
  buffer_load_dwordx4 v12, s[12:15], s75 offen offset:0 lds
  s_add_u32 m0, s79, 4096
  s_waitcnt lgkmcnt(10)
  v_mfma_f32_16x16x32_bf16 v[88:91], a[64:67], a[172:175], v[88:91]
  ds_read_b64_tr_b16 a[164:165], v193 offset:20704
  v_mfma_f32_16x16x32_bf16 v[92:95], a[68:71], a[172:175], v[92:95]
  ds_read_b64_tr_b16 a[166:167], v193 offset:21984
  s_waitcnt lgkmcnt(10)
  v_mfma_f32_16x16x32_bf16 v[96:99], a[64:67], a[176:179], v[96:99]
  ds_read_b64_tr_b16 a[168:169], v185 offset:23104
  v_mfma_f32_16x16x32_bf16 v[100:103], a[68:71], a[176:179], v[100:103]
  ds_read_b64_tr_b16 a[170:171], v185 offset:24384
  buffer_load_dwordx4 v40, s[8:11], s65 offen offset:0 lds
  s_waitcnt lgkmcnt(10)
  v_mfma_f32_16x16x32_bf16 v[104:107], a[64:67], a[180:183], v[104:107]
  ds_read_b64_tr_b16 a[172:173], v187 offset:23104
  v_mfma_f32_16x16x32_bf16 v[108:111], a[68:71], a[180:183], v[108:111]
  ds_read_b64_tr_b16 a[174:175], v187 offset:24384
  s_waitcnt lgkmcnt(10)
  v_mfma_f32_16x16x32_bf16 v[112:115], a[64:67], a[184:187], v[112:115]
  ds_read_b64_tr_b16 a[176:177], v189 offset:23104
  v_mfma_f32_16x16x32_bf16 v[116:119], a[68:71], a[184:187], v[116:119]
  ds_read_b64_tr_b16 a[178:179], v189 offset:24384
  buffer_load_dwordx4 v41, s[8:11], s65 offen offset:1024 lds
  s_waitcnt lgkmcnt(10)
  v_mfma_f32_16x16x32_bf16 v[120:123], a[64:67], a[188:191], v[120:123]
  ds_read_b64_tr_b16 a[180:181], v191 offset:23104
  v_mfma_f32_16x16x32_bf16 v[124:127], a[68:71], a[188:191], v[124:127]
  ds_read_b64_tr_b16 a[182:183], v191 offset:24384
  s_waitcnt lgkmcnt(10)
  v_mfma_f32_16x16x32_bf16 v[128:131], a[64:67], a[160:163], v[128:131]
  ds_read_b64_tr_b16 a[184:185], v193 offset:23104
  v_mfma_f32_16x16x32_bf16 v[132:135], a[68:71], a[160:163], v[132:135]
  ds_read_b64_tr_b16 a[186:187], v193 offset:24384
  buffer_load_dwordx4 v42, s[8:11], s65 offen offset:2048 lds
  s_waitcnt lgkmcnt(10)
  v_mfma_f32_16x16x32_bf16 v[136:139], a[64:67], a[164:167], v[136:139]
  ds_read_b64_tr_b16 a[188:189], v185 offset:23264
  v_mfma_f32_16x16x32_bf16 v[140:143], a[68:71], a[164:167], v[140:143]
  ds_read_b64_tr_b16 a[190:191], v185 offset:24544
  s_waitcnt lgkmcnt(10)
  v_mfma_f32_16x16x32_bf16 v[64:67], a[72:75], a[168:171], v[64:67]
  ds_read_b64_tr_b16 a[160:161], v187 offset:23264
  v_mfma_f32_16x16x32_bf16 v[68:71], a[76:79], a[168:171], v[68:71]
  ds_read_b64_tr_b16 a[162:163], v187 offset:24544
  buffer_load_dwordx4 v43, s[8:11], s65 offen offset:3072 lds
  s_waitcnt lgkmcnt(10)
  v_mfma_f32_16x16x32_bf16 v[72:75], a[72:75], a[172:175], v[72:75]
  ds_read_b64_tr_b16 a[164:165], v189 offset:23264
  v_mfma_f32_16x16x32_bf16 v[76:79], a[76:79], a[172:175], v[76:79]
  ds_read_b64_tr_b16 a[166:167], v189 offset:24544
  s_waitcnt lgkmcnt(10)
  v_mfma_f32_16x16x32_bf16 v[80:83], a[72:75], a[176:179], v[80:83]
  ds_read_b64_tr_b16 a[168:169], v191 offset:23264
  v_mfma_f32_16x16x32_bf16 v[84:87], a[76:79], a[176:179], v[84:87]
  ds_read_b64_tr_b16 a[170:171], v191 offset:24544
  s_waitcnt lgkmcnt(10)
  v_mfma_f32_16x16x32_bf16 v[88:91], a[72:75], a[180:183], v[88:91]
  ds_read_b64_tr_b16 a[172:173], v193 offset:23264
  v_mfma_f32_16x16x32_bf16 v[92:95], a[76:79], a[180:183], v[92:95]
  ds_read_b64_tr_b16 a[174:175], v193 offset:24544
  s_waitcnt vmcnt(22)
  s_waitcnt vmcnt(18)
  v_readfirstlane_b32 s39, v36
  s_nop 0
  s_cmp_lg_u32 s39, 0
  s_nop 2
  s_cbranch_scc1 L_havetag
  s_mov_b32 s46, 16384
L_spin0:
  v_mov_b32 v7, 0
  buffer_load_dword v36, v7, s[40:43], 0 offen sc1
  s_waitcnt vmcnt(0)
  v_readfirstlane_b32 s39, v36
  s_nop 0
  s_cmp_lg_u32 s39, 0
  s_nop 2
  s_cbranch_scc1 L_spun0
  s_sleep 1
  s_sub_u32 s46, s46, 1
  s_cmp_lg_u32 s46, 0
  s_cbranch_scc1 L_spin0
L_spun0:
L_havetag:
  s_cmp_lg_u32 s56, 0
  s_cbranch_scc1 L_nozf
  v_mov_b32 v6, s39
  v_mov_b32 v7, 0
  s_mov_b64 exec, 1
  buffer_store_dword v6, v7, s[24:27], s55 offen sc1
  s_mov_b64 exec, -1
L_nozf:
  s_or_b32 s38, s38, s39
  s_cmp_lg_u32 s31, 0
  s_cbranch_scc1 L_noxg
  s_lshl_b32 s3, s30, 2
  v_mov_b32 v6, s38
  v_mov_b32 v7, s3
  s_mov_b64 exec, 1
  buffer_store_dword v6, v7, s[24:27], s33 offen sc1
  s_mov_b64 exec, -1
L_noxg:
  s_barrier
  ds_read_b128 a[80:83], v44 offset:8192
  ds_read_b128 a[84:87], v44 offset:9216
  ds_read_b128 a[88:91], v45 offset:8192
  ds_read_b128 a[92:95], v45 offset:9216
  s_add_u32 m0, s36, 61632
  s_waitcnt lgkmcnt(14)
  v_mfma_f32_16x16x32_bf16 v[96:99], a[72:75], a[184:187], v[96:99]
  ds_read_b64_tr_b16 a[176:177], v184 offset:0
  v_mfma_f32_16x16x32_bf16 v[100:103], a[76:79], a[184:187], v[100:103]
  ds_read_b64_tr_b16 a[178:179], v184 offset:1280
  buffer_load_dwordx4 v8, s[12:15], s76 offen offset:0 lds
  s_waitcnt lgkmcnt(14)
  v_mfma_f32_16x16x32_bf16 v[104:107], a[72:75], a[188:191], v[104:107]
  ds_read_b64_tr_b16 a[180:181], v186 offset:0
  v_mfma_f32_16x16x32_bf16 v[108:111], a[76:79], a[188:191], v[108:111]
  ds_read_b64_tr_b16 a[182:183], v186 offset:1280
  s_waitcnt lgkmcnt(14)
  v_mfma_f32_16x16x32_bf16 v[112:115], a[72:75], a[160:163], v[112:115]
  ds_read_b64_tr_b16 a[184:185], v188 offset:0
  v_mfma_f32_16x16x32_bf16 v[116:119], a[76:79], a[160:163], v[116:119]
  ds_read_b64_tr_b16 a[186:187], v188 offset:1280
  buffer_load_dwordx4 v9, s[12:15], s76 offen offset:1024 lds
  s_waitcnt lgkmcnt(14)
  v_mfma_f32_16x16x32_bf16 v[120:123], a[72:75], a[164:167], v[120:123]
  ds_read_b64_tr_b16 a[188:189], v190 offset:0
  v_mfma_f32_16x16x32_bf16 v[124:127], a[76:79], a[164:167], v[124:127]
  ds_read_b64_tr_b16 a[190:191], v190 offset:1280
  s_waitcnt lgkmcnt(14)
  v_mfma_f32_16x16x32_bf16 v[128:131], a[72:75], a[168:171], v[128:131]
  ds_read_b64_tr_b16 a[160:161], v192 offset:0
  v_mfma_f32_16x16x32_bf16 v[132:135], a[76:79], a[168:171], v[132:135]
  ds_read_b64_tr_b16 a[162:163], v192 offset:1280
  buffer_load_dwordx4 v10, s[12:15], s76 offen offset:2048 lds
  s_waitcnt lgkmcnt(14)
  v_mfma_f32_16x16x32_bf16 v[136:139], a[72:75], a[172:175], v[136:139]
  ds_read_b64_tr_b16 a[164:165], v184 offset:160
  v_mfma_f32_16x16x32_bf16 v[140:143], a[76:79], a[172:175], v[140:143]
  ds_read_b64_tr_b16 a[166:167], v184 offset:1440
  s_waitcnt lgkmcnt(10)
  v_mfma_f32_16x16x32_bf16 v[64:67], a[80:83], a[176:179], v[64:67]
  ds_read_b64_tr_b16 a[168:169], v186 offset:160
  v_mfma_f32_16x16x32_bf16 v[68:71], a[84:87], a[176:179], v[68:71]
  ds_read_b64_tr_b16 a[170:171], v186 offset:1440
  buffer_load_dwordx4 v11, s[12:15], s76 offen offset:3072 lds
  s_add_u32 m0, s36, 65728
  s_waitcnt lgkmcnt(10)
  v_mfma_f32_16x16x32_bf16 v[72:75], a[80:83], a[180:183], v[72:75]
  ds_read_b64_tr_b16 a[172:173], v188 offset:160
  v_mfma_f32_16x16x32_bf16 v[76:79], a[84:87], a[180:183], v[76:79]
  ds_read_b64_tr_b16 a[174:175], v188 offset:1440
  s_waitcnt lgkmcnt(10)
  v_mfma_f32_16x16x32_bf16 v[80:83], a[80:83], a[184:187], v[80:83]
  ds_read_b64_tr_b16 a[176:177], v190 offset:160
  v_mfma_f32_16x16x32_bf16 v[84:87], a[84:87], a[184:187], v[84:87]
  ds_read_b64_tr_b16 a[178:179], v190 offset:1440
  buffer_load_dwordx4 v12, s[12:15], s76 offen offset:0 lds
  s_add_u32 m0, s79, 8192
  s_waitcnt lgkmcnt(10)
  v_mfma_f32_16x16x32_bf16 v[88:91], a[80:83], a[188:191], v[88:91]
  ds_read_b64_tr_b16 a[180:181], v192 offset:160
  v_mfma_f32_16x16x32_bf16 v[92:95], a[84:87], a[188:191], v[92:95]
  ds_read_b64_tr_b16 a[182:183], v192 offset:1440
  s_waitcnt lgkmcnt(10)
  v_mfma_f32_16x16x32_bf16 v[96:99], a[80:83], a[160:163], v[96:99]
  ds_read_b64_tr_b16 a[184:185], v184 offset:2560
  v_mfma_f32_16x16x32_bf16 v[100:103], a[84:87], a[160:163], v[100:103]
  ds_read_b64_tr_b16 a[186:187], v184 offset:3840
  buffer_load_dwordx4 v40, s[8:11], s66 offen offset:0 lds
  s_waitcnt lgkmcnt(10)
  v_mfma_f32_16x16x32_bf16 v[104:107], a[80:83], a[164:167], v[104:107]
  ds_read_b64_tr_b16 a[188:189], v186 offset:2560
  v_mfma_f32_16x16x32_bf16 v[108:111], a[84:87], a[164:167], v[108:111]
  ds_read_b64_tr_b16 a[190:191], v186 offset:3840
  s_waitcnt lgkmcnt(10)
  v_mfma_f32_16x16x32_bf16 v[112:115], a[80:83], a[168:171], v[112:115]
  ds_read_b64_tr_b16 a[160:161], v188 offset:2560
  v_mfma_f32_16x16x32_bf16 v[116:119], a[84:87], a[168:171], v[116:119]
  ds_read_b64_tr_b16 a[162:163], v188 offset:3840
  buffer_load_dwordx4 v41, s[8:11], s66 offen offset:1024 lds
  s_waitcnt lgkmcnt(10)
  v_mfma_f32_16x16x32_bf16 v[120:123], a[80:83], a[172:175], v[120:123]
  ds_read_b64_tr_b16 a[164:165], v190 offset:2560
  v_mfma_f32_16x16x32_bf16 v[124:127], a[84:87], a[172:175], v[124:127]
  ds_read_b64_tr_b16 a[166:167], v190 offset:3840
  s_waitcnt lgkmcnt(10)
  v_mfma_f32_16x16x32_bf16 v[128:131], a[80:83], a[176:179], v[128:131]
  ds_read_b64_tr_b16 a[168:169], v192 offset:2560
  v_mfma_f32_16x16x32_bf16 v[132:135], a[84:87], a[176:179], v[132:135]
  ds_read_b64_tr_b16 a[170:171], v192 offset:3840
  buffer_load_dwordx4 v42, s[8:11], s66 offen offset:2048 lds
  s_waitcnt lgkmcnt(10)
  v_mfma_f32_16x16x32_bf16 v[136:139], a[80:83], a[180:183], v[136:139]
  ds_read_b64_tr_b16 a[172:173], v184 offset:2720
  v_mfma_f32_16x16x32_bf16 v[140:143], a[84:87], a[180:183], v[140:143]
  ds_read_b64_tr_b16 a[174:175], v184 offset:4000
  s_waitcnt lgkmcnt(10)
  v_mfma_f32_16x16x32_bf16 v[64:67], a[88:91], a[184:187], v[64:67]
  ds_read_b64_tr_b16 a[176:177], v186 offset:2720
  v_mfma_f32_16x16x32_bf16 v[68:71], a[92:95], a[184:187], v[68:71]
  ds_read_b64_tr_b16 a[178:179], v186 offset:4000
  buffer_load_dwordx4 v43, s[8:11], s66 offen offset:3072 lds
  s_waitcnt lgkmcnt(10)
  v_mfma_f32_16x16x32_bf16 v[72:75], a[88:91], a[188:191], v[72:75]
  ds_read_b64_tr_b16 a[180:181], v188 offset:2720
  v_mfma_f32_16x16x32_bf16 v[76:79], a[92:95], a[188:191], v[76:79]
  ds_read_b64_tr_b16 a[182:183], v188 offset:4000
  s_waitcnt lgkmcnt(10)
  v_mfma_f32_16x16x32_bf16 v[80:83], a[88:91], a[160:163], v[80:83]
  ds_read_b64_tr_b16 a[184:185], v190 offset:2720
  v_mfma_f32_16x16x32_bf16 v[84:87], a[92:95], a[160:163], v[84:87]
  ds_read_b64_tr_b16 a[186:187], v190 offset:4000
  s_waitcnt lgkmcnt(10)
  v_mfma_f32_16x16x32_bf16 v[88:91], a[88:91], a[164:167], v[88:91]
  ds_read_b64_tr_b16 a[188:189], v192 offset:2720
  v_mfma_f32_16x16x32_bf16 v[92:95], a[92:95], a[164:167], v[92:95]
  ds_read_b64_tr_b16 a[190:191], v192 offset:4000
  s_waitcnt vmcnt(22)
  s_waitcnt vmcnt(18)
  s_barrier
  ds_read_b128 a[96:99], v44 offset:0
  ds_read_b128 a[100:103], v44 offset:1024
  ds_read_b128 a[104:107], v45 offset:0
  ds_read_b128 a[108:111], v45 offset:1024
  s_add_u32 m0, s36, 82176
  s_waitcnt lgkmcnt(14)
  v_mfma_f32_16x16x32_bf16 v[96:99], a[88:91], a[168:171], v[96:99]
  ds_read_b64_tr_b16 a[160:161], v184 offset:20544
  v_mfma_f32_16x16x32_bf16 v[100:103], a[92:95], a[168:171], v[100:103]
  ds_read_b64_tr_b16 a[162:163], v184 offset:21824
  buffer_load_dwordx4 v8, s[12:15], s77 offen offset:0 lds
  s_waitcnt lgkmcnt(14)
  v_mfma_f32_16x16x32_bf16 v[104:107], a[88:91], a[172:175], v[104:107]
  ds_read_b64_tr_b16 a[164:165], v186 offset:20544
  v_mfma_f32_16x16x32_bf16 v[108:111], a[92:95], a[172:175], v[108:111]
  ds_read_b64_tr_b16 a[166:167], v186 offset:21824
  s_waitcnt lgkmcnt(14)
  v_mfma_f32_16x16x32_bf16 v[112:115], a[88:91], a[176:179], v[112:115]
  ds_read_b64_tr_b16 a[168:169], v188 offset:20544
  v_mfma_f32_16x16x32_bf16 v[116:119], a[92:95], a[176:179], v[116:119]
  ds_read_b64_tr_b16 a[170:171], v188 offset:21824
  buffer_load_dwordx4 v9, s[12:15], s77 offen offset:1024 lds
  s_waitcnt lgkmcnt(14)
  v_mfma_f32_16x16x32_bf16 v[120:123], a[88:91], a[180:183], v[120:123]
  ds_read_b64_tr_b16 a[172:173], v190 offset:20544
  v_mfma_f32_16x16x32_bf16 v[124:127], a[92:95], a[180:183], v[124:127]
  ds_read_b64_tr_b16 a[174:175], v190 offset:21824
  s_waitcnt lgkmcnt(14)
  v_mfma_f32_16x16x32_bf16 v[128:131], a[88:91], a[184:187], v[128:131]
  ds_read_b64_tr_b16 a[176:177], v192 offset:20544
  v_mfma_f32_16x16x32_bf16 v[132:135], a[92:95], a[184:187], v[132:135]
  ds_read_b64_tr_b16 a[178:179], v192 offset:21824
  buffer_load_dwordx4 v10, s[12:15], s77 offen offset:2048 lds
  s_waitcnt lgkmcnt(14)
  v_mfma_f32_16x16x32_bf16 v[136:139], a[88:91], a[188:191], v[136:139]
  ds_read_b64_tr_b16 a[180:181], v184 offset:20704
  v_mfma_f32_16x16x32_bf16 v[140:143], a[92:95], a[188:191], v[140:143]
  ds_read_b64_tr_b16 a[182:183], v184 offset:21984
  s_waitcnt lgkmcnt(10)
  v_mfma_f32_16x16x32_bf16 v[64:67], a[96:99], a[160:163], v[64:67]
  ds_read_b64_tr_b16 a[184:185], v186 offset:20704
  v_mfma_f32_16x16x32_bf16 v[68:71], a[100:103], a[160:163], v[68:71]
  ds_read_b64_tr_b16 a[186:187], v186 offset:21984
  buffer_load_dwordx4 v11, s[12:15], s77 offen offset:3072 lds
  s_add_u32 m0, s36, 86272
  s_waitcnt lgkmcnt(10)
  v_mfma_f32_16x16x32_bf16 v[72:75], a[96:99], a[164:167], v[72:75]
  ds_read_b64_tr_b16 a[188:189], v188 offset:20704
  v_mfma_f32_16x16x32_bf16 v[76:79], a[100:103], a[164:167], v[76:79]
  ds_read_b64_tr_b16 a[190:191], v188 offset:21984
  s_waitcnt lgkmcnt(10)
  v_mfma_f32_16x16x32_bf16 v[80:83], a[96:99], a[168:171], v[80:83]
  ds_read_b64_tr_b16 a[160:161], v190 offset:20704
  v_mfma_f32_16x16x32_bf16 v[84:87], a[100:103], a[168:171], v[84:87]
  ds_read_b64_tr_b16 a[162:163], v190 offset:21984
  buffer_load_dwordx4 v12, s[12:15], s77 offen offset:0 lds
  s_mov_b32 m0, s79
  s_waitcnt lgkmcnt(10)
  v_mfma_f32_16x16x32_bf16 v[88:91], a[96:99], a[172:175], v[88:91]
  ds_read_b64_tr_b16 a[164:165], v192 offset:20704
  v_mfma_f32_16x16x32_bf16 v[92:95], a[100:103], a[172:175], v[92:95]
  ds_read_b64_tr_b16 a[166:167], v192 offset:21984
  s_waitcnt lgkmcnt(10)
  v_mfma_f32_16x16x32_bf16 v[96:99], a[96:99], a[176:179], v[96:99]
  ds_read_b64_tr_b16 a[168:169], v184 offset:23104
  v_mfma_f32_16x16x32_bf16 v[100:103], a[100:103], a[176:179], v[100:103]
  ds_read_b64_tr_b16 a[170:171], v184 offset:24384
  buffer_load_dwordx4 v40, s[8:11], s67 offen offset:0 lds
  s_waitcnt lgkmcnt(10)
  v_mfma_f32_16x16x32_bf16 v[104:107], a[96:99], a[180:183], v[104:107]
  ds_read_b64_tr_b16 a[172:173], v186 offset:23104
  v_mfma_f32_16x16x32_bf16 v[108:111], a[100:103], a[180:183], v[108:111]
  ds_read_b64_tr_b16 a[174:175], v186 offset:24384
  s_waitcnt lgkmcnt(10)
  v_mfma_f32_16x16x32_bf16 v[112:115], a[96:99], a[184:187], v[112:115]
  ds_read_b64_tr_b16 a[176:177], v188 offset:23104
  v_mfma_f32_16x16x32_bf16 v[116:119], a[100:103], a[184:187], v[116:119]
  ds_read_b64_tr_b16 a[178:179], v188 offset:24384
  buffer_load_dwordx4 v41, s[8:11], s67 offen offset:1024 lds
  s_waitcnt lgkmcnt(10)
  v_mfma_f32_16x16x32_bf16 v[120:123], a[96:99], a[188:191], v[120:123]
  ds_read_b64_tr_b16 a[180:181], v190 offset:23104
  v_mfma_f32_16x16x32_bf16 v[124:127], a[100:103], a[188:191], v[124:127]
  ds_read_b64_tr_b16 a[182:183], v190 offset:24384
  s_waitcnt lgkmcnt(10)
  v_mfma_f32_16x16x32_bf16 v[128:131], a[96:99], a[160:163], v[128:131]
  ds_read_b64_tr_b16 a[184:185], v192 offset:23104
  v_mfma_f32_16x16x32_bf16 v[132:135], a[100:103], a[160:163], v[132:135]
  ds_read_b64_tr_b16 a[186:187], v192 offset:24384
  buffer_load_dwordx4 v42, s[8:11], s67 offen offset:2048 lds
  s_waitcnt lgkmcnt(10)
  v_mfma_f32_16x16x32_bf16 v[136:139], a[96:99], a[164:167], v[136:139]
  ds_read_b64_tr_b16 a[188:189], v184 offset:23264
  v_mfma_f32_16x16x32_bf16 v[140:143], a[100:103], a[164:167], v[140:143]
  ds_read_b64_tr_b16 a[190:191], v184 offset:24544
  s_waitcnt lgkmcnt(10)
  v_mfma_f32_16x16x32_bf16 v[64:67], a[104:107], a[168:171], v[64:67]
  ds_read_b64_tr_b16 a[160:161], v186 offset:23264
  v_mfma_f32_16x16x32_bf16 v[68:71], a[108:111], a[168:171], v[68:71]
  ds_read_b64_tr_b16 a[162:163], v186 offset:24544
  buffer_load_dwordx4 v43, s[8:11], s67 offen offset:3072 lds
  s_waitcnt lgkmcnt(10)
  v_mfma_f32_16x16x32_bf16 v[72:75], a[104:107], a[172:175], v[72:75]
  ds_read_b64_tr_b16 a[164:165], v188 offset:23264
  v_mfma_f32_16x16x32_bf16 v[76:79], a[108:111], a[172:175], v[76:79]
  ds_read_b64_tr_b16 a[166:167], v188 offset:24544
  s_waitcnt lgkmcnt(10)
  v_mfma_f32_16x16x32_bf16 v[80:83], a[104:107], a[176:179], v[80:83]
  ds_read_b64_tr_b16 a[168:169], v190 offset:23264
  v_mfma_f32_16x16x32_bf16 v[84:87], a[108:111], a[176:179], v[84:87]
  ds_read_b64_tr_b16 a[170:171], v190 offset:24544
  s_waitcnt lgkmcnt(10)
  v_mfma_f32_16x16x32_bf16 v[88:91], a[104:107], a[180:183], v[88:91]
  ds_read_b64_tr_b16 a[172:173], v192 offset:23264
  v_mfma_f32_16x16x32_bf16 v[92:95], a[108:111], a[180:183], v[92:95]
  ds_read_b64_tr_b16 a[174:175], v192 offset:24544
  s_waitcnt vmcnt(22)
  s_waitcnt vmcnt(18)
  s_barrier
  ds_read_b128 a[112:115], v44 offset:4096
  ds_read_b128 a[116:119], v44 offset:5120
  ds_read_b128 a[120:123], v45 offset:4096
  ds_read_b128 a[124:127], v45 offset:5120
  s_mov_b32 m0, s36
  s_waitcnt lgkmcnt(14)
  v_mfma_f32_16x16x32_bf16 v[96:99], a[104:107], a[184:187], v[96:99]
  ds_read_b64_tr_b16 a[176:177], v184 offset:41088
  v_mfma_f32_16x16x32_bf16 v[100:103], a[108:111], a[184:187], v[100:103]
  ds_read_b64_tr_b16 a[178:179], v184 offset:42368
  buffer_load_dwordx4 v13, s[12:15], s68 offen offset:0 lds
  s_waitcnt lgkmcnt(14)
  v_mfma_f32_16x16x32_bf16 v[104:107], a[104:107], a[188:191], v[104:107]
  ds_read_b64_tr_b16 a[180:181], v186 offset:41088
  v_mfma_f32_16x16x32_bf16 v[108:111], a[108:111], a[188:191], v[108:111]
  ds_read_b64_tr_b16 a[182:183], v186 offset:42368
  s_waitcnt lgkmcnt(14)
  v_mfma_f32_16x16x32_bf16 v[112:115], a[104:107], a[160:163], v[112:115]
  ds_read_b64_tr_b16 a[184:185], v188 offset:41088
  v_mfma_f32_16x16x32_bf16 v[116:119], a[108:111], a[160:163], v[116:119]
  ds_read_b64_tr_b16 a[186:187], v188 offset:42368
  buffer_load_dwordx4 v14, s[12:15], s68 offen offset:1024 lds
  s_waitcnt lgkmcnt(14)
  v_mfma_f32_16x16x32_bf16 v[120:123], a[104:107], a[164:167], v[120:123]
  ds_read_b64_tr_b16 a[188:189], v190 offset:41088
  v_mfma_f32_16x16x32_bf16 v[124:127], a[108:111], a[164:167], v[124:127]
  ds_read_b64_tr_b16 a[190:191], v190 offset:42368
  s_waitcnt lgkmcnt(14)
  v_mfma_f32_16x16x32_bf16 v[128:131], a[104:107], a[168:171], v[128:131]
  ds_read_b64_tr_b16 a[160:161], v192 offset:41088
  v_mfma_f32_16x16x32_bf16 v[132:135], a[108:111], a[168:171], v[132:135]
  ds_read_b64_tr_b16 a[162:163], v192 offset:42368
  buffer_load_dwordx4 v15, s[12:15], s68 offen offset:2048 lds
  s_waitcnt lgkmcnt(14)
  v_mfma_f32_16x16x32_bf16 v[136:139], a[104:107], a[172:175], v[136:139]
  ds_read_b64_tr_b16 a[164:165], v184 offset:41248
  v_mfma_f32_16x16x32_bf16 v[140:143], a[108:111], a[172:175], v[140:143]
  ds_read_b64_tr_b16 a[166:167], v184 offset:42528
  s_waitcnt lgkmcnt(10)
  v_mfma_f32_16x16x32_bf16 v[64:67], a[112:115], a[176:179], v[64:67]
  ds_read_b64_tr_b16 a[168:169], v186 offset:41248
  v_mfma_f32_16x16x32_bf16 v[68:71], a[116:119], a[176:179], v[68:71]
  ds_read_b64_tr_b16 a[170:171], v186 offset:42528
  buffer_load_dwordx4 v16, s[12:15], s68 offen offset:3072 lds
  s_add_u32 m0, s36, 4096
  s_waitcnt lgkmcnt(10)
  v_mfma_f32_16x16x32_bf16 v[72:75], a[112:115], a[180:183], v[72:75]
  ds_read_b64_tr_b16 a[172:173], v188 offset:41248
  v_mfma_f32_16x16x32_bf16 v[76:79], a[116:119], a[180:183], v[76:79]
  ds_read_b64_tr_b16 a[174:175], v188 offset:42528
  s_waitcnt lgkmcnt(10)
  v_mfma_f32_16x16x32_bf16 v[80:83], a[112:115], a[184:187], v[80:83]
  ds_read_b64_tr_b16 a[176:177], v190 offset:41248
  v_mfma_f32_16x16x32_bf16 v[84:87], a[116:119], a[184:187], v[84:87]
  ds_read_b64_tr_b16 a[178:179], v190 offset:42528
  buffer_load_dwordx4 v17, s[12:15], s68 offen offset:0 lds
  s_waitcnt lgkmcnt(10)
  v_mfma_f32_16x16x32_bf16 v[88:91], a[112:115], a[188:191], v[88:91]
  ds_read_b64_tr_b16 a[180:181], v192 offset:41248
  v_mfma_f32_16x16x32_bf16 v[92:95], a[116:119], a[188:191], v[92:95]
  ds_read_b64_tr_b16 a[182:183], v192 offset:42528
  s_waitcnt lgkmcnt(10)
  v_mfma_f32_16x16x32_bf16 v[96:99], a[112:115], a[160:163], v[96:99]
  ds_read_b64_tr_b16 a[184:185], v184 offset:43648
  v_mfma_f32_16x16x32_bf16 v[100:103], a[116:119], a[160:163], v[100:103]
  ds_read_b64_tr_b16 a[186:187], v184 offset:44928
  s_waitcnt lgkmcnt(10)
  v_mfma_f32_16x16x32_bf16 v[104:107], a[112:115], a[164:167], v[104:107]
  ds_read_b64_tr_b16 a[188:189], v186 offset:43648
  v_mfma_f32_16x16x32_bf16 v[108:111], a[116:119], a[164:167], v[108:111]
  ds_read_b64_tr_b16 a[190:191], v186 offset:44928
  s_waitcnt lgkmcnt(10)
  v_mfma_f32_16x16x32_bf16 v[112:115], a[112:115], a[168:171], v[112:115]
  ds_read_b64_tr_b16 a[160:161], v188 offset:43648
  v_mfma_f32_16x16x32_bf16 v[116:119], a[116:119], a[168:171], v[116:119]
  ds_read_b64_tr_b16 a[162:163], v188 offset:44928
  s_waitcnt lgkmcnt(10)
  v_mfma_f32_16x16x32_bf16 v[120:123], a[112:115], a[172:175], v[120:123]
  ds_read_b64_tr_b16 a[164:165], v190 offset:43648
  v_mfma_f32_16x16x32_bf16 v[124:127], a[116:119], a[172:175], v[124:127]
  ds_read_b64_tr_b16 a[166:167], v190 offset:44928
  s_waitcnt lgkmcnt(10)
  v_mfma_f32_16x16x32_bf16 v[128:131], a[112:115], a[176:179], v[128:131]
  ds_read_b64_tr_b16 a[168:169], v192 offset:43648
  v_mfma_f32_16x16x32_bf16 v[132:135], a[116:119], a[176:179], v[132:135]
  ds_read_b64_tr_b16 a[170:171], v192 offset:44928
  s_waitcnt lgkmcnt(10)
  v_mfma_f32_16x16x32_bf16 v[136:139], a[112:115], a[180:183], v[136:139]
  ds_read_b64_tr_b16 a[172:173], v184 offset:43808
  v_mfma_f32_16x16x32_bf16 v[140:143], a[116:119], a[180:183], v[140:143]
  ds_read_b64_tr_b16 a[174:175], v184 offset:45088
  s_waitcnt lgkmcnt(10)
  v_mfma_f32_16x16x32_bf16 v[64:67], a[120:123], a[184:187], v[64:67]
  ds_read_b64_tr_b16 a[176:177], v186 offset:43808
  v_mfma_f32_16x16x32_bf16 v[68:71], a[124:127], a[184:187], v[68:71]
  ds_read_b64_tr_b16 a[178:179], v186 offset:45088
  s_waitcnt lgkmcnt(10)
  v_mfma_f32_16x16x32_bf16 v[72:75], a[120:123], a[188:191], v[72:75]
  ds_read_b64_tr_b16 a[180:181], v188 offset:43808
  v_mfma_f32_16x16x32_bf16 v[76:79], a[124:127], a[188:191], v[76:79]
  ds_read_b64_tr_b16 a[182:183], v188 offset:45088
  s_waitcnt lgkmcnt(10)
  v_mfma_f32_16x16x32_bf16 v[80:83], a[120:123], a[160:163], v[80:83]
  ds_read_b64_tr_b16 a[184:185], v190 offset:43808
  v_mfma_f32_16x16x32_bf16 v[84:87], a[124:127], a[160:163], v[84:87]
  ds_read_b64_tr_b16 a[186:187], v190 offset:45088
  s_waitcnt lgkmcnt(10)
  v_mfma_f32_16x16x32_bf16 v[88:91], a[120:123], a[164:167], v[88:91]
  ds_read_b64_tr_b16 a[188:189], v192 offset:43808
  v_mfma_f32_16x16x32_bf16 v[92:95], a[124:127], a[164:167], v[92:95]
  ds_read_b64_tr_b16 a[190:191], v192 offset:45088
  s_waitcnt vmcnt(18)
  s_waitcnt vmcnt(14)
  s_barrier
  ds_read_b128 a[128:131], v44 offset:8192
  ds_read_b128 a[132:135], v44 offset:9216
  ds_read_b128 a[136:139], v45 offset:8192
  ds_read_b128 a[140:143], v45 offset:9216
  s_add_u32 m0, s36, 20544
  s_waitcnt lgkmcnt(14)
  v_mfma_f32_16x16x32_bf16 v[96:99], a[120:123], a[168:171], v[96:99]
  ds_read_b64_tr_b16 a[160:161], v185 offset:0
  v_mfma_f32_16x16x32_bf16 v[100:103], a[124:127], a[168:171], v[100:103]
  ds_read_b64_tr_b16 a[162:163], v185 offset:1280
  buffer_load_dwordx4 v13, s[12:15], s70 offen offset:0 lds
  s_waitcnt lgkmcnt(14)
  v_mfma_f32_16x16x32_bf16 v[104:107], a[120:123], a[172:175], v[104:107]
  ds_read_b64_tr_b16 a[164:165], v187 offset:0
  v_mfma_f32_16x16x32_bf16 v[108:111], a[124:127], a[172:175], v[108:111]
  ds_read_b64_tr_b16 a[166:167], v187 offset:1280
  s_waitcnt lgkmcnt(14)
  v_mfma_f32_16x16x32_bf16 v[112:115], a[120:123], a[176:179], v[112:115]
  ds_read_b64_tr_b16 a[168:169], v189 offset:0
  v_mfma_f32_16x16x32_bf16 v[116:119], a[124:127], a[176:179], v[116:119]
  ds_read_b64_tr_b16 a[170:171], v189 offset:1280
  buffer_load_dwordx4 v14, s[12:15], s70 offen offset:1024 lds
  s_waitcnt lgkmcnt(14)
  v_mfma_f32_16x16x32_bf16 v[120:123], a[120:123], a[180:183], v[120:123]
  ds_read_b64_tr_b16 a[172:173], v191 offset:0
  v_mfma_f32_16x16x32_bf16 v[124:127], a[124:127], a[180:183], v[124:127]
  ds_read_b64_tr_b16 a[174:175], v191 offset:1280
  s_waitcnt lgkmcnt(14)
  v_mfma_f32_16x16x32_bf16 v[128:131], a[120:123], a[184:187], v[128:131]
  ds_read_b64_tr_b16 a[176:177], v193 offset:0
  v_mfma_f32_16x16x32_bf16 v[132:135], a[124:127], a[184:187], v[132:135]
  ds_read_b64_tr_b16 a[178:179], v193 offset:1280
  buffer_load_dwordx4 v15, s[12:15], s70 offen offset:2048 lds
  s_waitcnt lgkmcnt(14)
  v_mfma_f32_16x16x32_bf16 v[136:139], a[120:123], a[188:191], v[136:139]
  ds_read_b64_tr_b16 a[180:181], v185 offset:160
  v_mfma_f32_16x16x32_bf16 v[140:143], a[124:127], a[188:191], v[140:143]
  ds_read_b64_tr_b16 a[182:183], v185 offset:1440
  s_waitcnt lgkmcnt(10)
  v_mfma_f32_16x16x32_bf16 v[64:67], a[128:131], a[160:163], v[64:67]
  ds_read_b64_tr_b16 a[184:185], v187 offset:160
  v_mfma_f32_16x16x32_bf16 v[68:71], a[132:135], a[160:163], v[68:71]
  ds_read_b64_tr_b16 a[186:187], v187 offset:1440
  buffer_load_dwordx4 v16, s[12:15], s70 offen offset:3072 lds
  s_add_u32 m0, s36, 24640
  s_waitcnt lgkmcnt(10)
  v_mfma_f32_16x16x32_bf16 v[72:75], a[128:131], a[164:167], v[72:75]
  ds_read_b64_tr_b16 a[188:189], v189 offset:160
  v_mfma_f32_16x16x32_bf16 v[76:79], a[132:135], a[164:167], v[76:79]
  ds_read_b64_tr_b16 a[190:191], v189 offset:1440
  s_waitcnt lgkmcnt(10)
  v_mfma_f32_16x16x32_bf16 v[80:83], a[128:131], a[168:171], v[80:83]
  ds_read_b64_tr_b16 a[160:161], v191 offset:160
  v_mfma_f32_16x16x32_bf16 v[84:87], a[132:135], a[168:171], v[84:87]
  ds_read_b64_tr_b16 a[162:163], v191 offset:1440
  buffer_load_dwordx4 v17, s[12:15], s70 offen offset:0 lds
  s_waitcnt lgkmcnt(10)
  v_mfma_f32_16x16x32_bf16 v[88:91], a[128:131], a[172:175], v[88:91]
  ds_read_b64_tr_b16 a[164:165], v193 offset:160
  v_mfma_f32_16x16x32_bf16 v[92:95], a[132:135], a[172:175], v[92:95]
  ds_read_b64_tr_b16 a[166:167], v193 offset:1440
  s_waitcnt lgkmcnt(10)
  v_mfma_f32_16x16x32_bf16 v[96:99], a[128:131], a[176:179], v[96:99]
  ds_read_b64_tr_b16 a[168:169], v185 offset:2560
  v_mfma_f32_16x16x32_bf16 v[100:103], a[132:135], a[176:179], v[100:103]
  ds_read_b64_tr_b16 a[170:171], v185 offset:3840
  s_waitcnt lgkmcnt(10)
  v_mfma_f32_16x16x32_bf16 v[104:107], a[128:131], a[180:183], v[104:107]
  ds_read_b64_tr_b16 a[172:173], v187 offset:2560
  v_mfma_f32_16x16x32_bf16 v[108:111], a[132:135], a[180:183], v[108:111]
  ds_read_b64_tr_b16 a[174:175], v187 offset:3840
  s_waitcnt lgkmcnt(10)
  v_mfma_f32_16x16x32_bf16 v[112:115], a[128:131], a[184:187], v[112:115]
  ds_read_b64_tr_b16 a[176:177], v189 offset:2560
  v_mfma_f32_16x16x32_bf16 v[116:119], a[132:135], a[184:187], v[116:119]
  ds_read_b64_tr_b16 a[178:179], v189 offset:3840
  s_waitcnt lgkmcnt(10)
  v_mfma_f32_16x16x32_bf16 v[120:123], a[128:131], a[188:191], v[120:123]
  ds_read_b64_tr_b16 a[180:181], v191 offset:2560
  v_mfma_f32_16x16x32_bf16 v[124:127], a[132:135], a[188:191], v[124:127]
  ds_read_b64_tr_b16 a[182:183], v191 offset:3840
  s_waitcnt lgkmcnt(10)
  v_mfma_f32_16x16x32_bf16 v[128:131], a[128:131], a[160:163], v[128:131]
  ds_read_b64_tr_b16 a[184:185], v193 offset:2560
  v_mfma_f32_16x16x32_bf16 v[132:135], a[132:135], a[160:163], v[132:135]
  ds_read_b64_tr_b16 a[186:187], v193 offset:3840
  s_waitcnt lgkmcnt(10)
  v_mfma_f32_16x16x32_bf16 v[136:139], a[128:131], a[164:167], v[136:139]
  ds_read_b64_tr_b16 a[188:189], v185 offset:2720
  v_mfma_f32_16x16x32_bf16 v[140:143], a[132:135], a[164:167], v[140:143]
  ds_read_b64_tr_b16 a[190:191], v185 offset:4000
  s_waitcnt lgkmcnt(10)
  v_mfma_f32_16x16x32_bf16 v[64:67], a[136:139], a[168:171], v[64:67]
  ds_read_b64_tr_b16 a[160:161], v187 offset:2720
  v_mfma_f32_16x16x32_bf16 v[68:71], a[140:143], a[168:171], v[68:71]
  ds_read_b64_tr_b16 a[162:163], v187 offset:4000
  s_waitcnt lgkmcnt(10)
  v_mfma_f32_16x16x32_bf16 v[72:75], a[136:139], a[172:175], v[72:75]
  ds_read_b64_tr_b16 a[164:165], v189 offset:2720
  v_mfma_f32_16x16x32_bf16 v[76:79], a[140:143], a[172:175], v[76:79]
  ds_read_b64_tr_b16 a[166:167], v189 offset:4000
  s_waitcnt lgkmcnt(10)
  v_mfma_f32_16x16x32_bf16 v[80:83], a[136:139], a[176:179], v[80:83]
  ds_read_b64_tr_b16 a[168:169], v191 offset:2720
  v_mfma_f32_16x16x32_bf16 v[84:87], a[140:143], a[176:179], v[84:87]
  ds_read_b64_tr_b16 a[170:171], v191 offset:4000
  s_waitcnt lgkmcnt(10)
  v_mfma_f32_16x16x32_bf16 v[88:91], a[136:139], a[180:183], v[88:91]
  ds_read_b64_tr_b16 a[172:173], v193 offset:2720
  v_mfma_f32_16x16x32_bf16 v[92:95], a[140:143], a[180:183], v[92:95]
  ds_read_b64_tr_b16 a[174:175], v193 offset:4000
  s_waitcnt vmcnt(14)
  s_waitcnt vmcnt(10)
  s_barrier
  ds_read_b128 a[144:147], v44 offset:0
  ds_read_b128 a[148:151], v44 offset:1024
  ds_read_b128 a[152:155], v45 offset:0
  ds_read_b128 a[156:159], v45 offset:1024
  v_mov_b32 v7, 0
  buffer_load_dword v36, v7, s[24:27], s55 offen sc1
  s_add_u32 m0, s36, 41088
  s_waitcnt lgkmcnt(14)
  v_mfma_f32_16x16x32_bf16 v[96:99], a[136:139], a[184:187], v[96:99]
  ds_read_b64_tr_b16 a[176:177], v185 offset:20544
  v_mfma_f32_16x16x32_bf16 v[100:103], a[140:143], a[184:187], v[100:103]
  ds_read_b64_tr_b16 a[178:179], v185 offset:21824
  buffer_load_dwordx4 v13, s[12:15], s72 offen offset:0 lds
  s_waitcnt lgkmcnt(14)
  v_mfma_f32_16x16x32_bf16 v[104:107], a[136:139], a[188:191], v[104:107]
  ds_read_b64_tr_b16 a[180:181], v187 offset:20544
  v_mfma_f32_16x16x32_bf16 v[108:111], a[140:143], a[188:191], v[108:111]
  ds_read_b64_tr_b16 a[182:183], v187 offset:21824
  s_waitcnt lgkmcnt(14)
  v_mfma_f32_16x16x32_bf16 v[112:115], a[136:139], a[160:163], v[112:115]
  ds_read_b64_tr_b16 a[184:185], v189 offset:20544
  v_mfma_f32_16x16x32_bf16 v[116:119], a[140:143], a[160:163], v[116:119]
  ds_read_b64_tr_b16 a[186:187], v189 offset:21824
  buffer_load_dwordx4 v14, s[12:15], s72 offen offset:1024 lds
  s_waitcnt lgkmcnt(14)
  v_mfma_f32_16x16x32_bf16 v[120:123], a[136:139], a[164:167], v[120:123]
  ds_read_b64_tr_b16 a[188:189], v191 offset:20544
  v_mfma_f32_16x16x32_bf16 v[124:127], a[140:143], a[164:167], v[124:127]
  ds_read_b64_tr_b16 a[190:191], v191 offset:21824
  s_waitcnt lgkmcnt(14)
  v_mfma_f32_16x16x32_bf16 v[128:131], a[136:139], a[168:171], v[128:131]
  ds_read_b64_tr_b16 a[160:161], v193 offset:20544
  v_mfma_f32_16x16x32_bf16 v[132:135], a[140:143], a[168:171], v[132:135]
  ds_read_b64_tr_b16 a[162:163], v193 offset:21824
  buffer_load_dwordx4 v15, s[12:15], s72 offen offset:2048 lds
  s_waitcnt lgkmcnt(14)
  v_mfma_f32_16x16x32_bf16 v[136:139], a[136:139], a[172:175], v[136:139]
  ds_read_b64_tr_b16 a[164:165], v185 offset:20704
  v_mfma_f32_16x16x32_bf16 v[140:143], a[140:143], a[172:175], v[140:143]
  ds_read_b64_tr_b16 a[166:167], v185 offset:21984
  s_waitcnt lgkmcnt(10)
  v_mfma_f32_16x16x32_bf16 v[64:67], a[144:147], a[176:179], v[64:67]
  ds_read_b64_tr_b16 a[168:169], v187 offset:20704
  v_mfma_f32_16x16x32_bf16 v[68:71], a[148:151], a[176:179], v[68:71]
  ds_read_b64_tr_b16 a[170:171], v187 offset:21984
  buffer_load_dwordx4 v16, s[12:15], s72 offen offset:3072 lds
  s_add_u32 m0, s36, 45184
  s_waitcnt lgkmcnt(10)
  v_mfma_f32_16x16x32_bf16 v[72:75], a[144:147], a[180:183], v[72:75]
  ds_read_b64_tr_b16 a[172:173], v189 offset:20704
  v_mfma_f32_16x16x32_bf16 v[76:79], a[148:151], a[180:183], v[76:79]
  ds_read_b64_tr_b16 a[174:175], v189 offset:21984
  s_waitcnt lgkmcnt(10)
  v_mfma_f32_16x16x32_bf16 v[80:83], a[144:147], a[184:187], v[80:83]
  ds_read_b64_tr_b16 a[176:177], v191 offset:20704
  v_mfma_f32_16x16x32_bf16 v[84:87], a[148:151], a[184:187], v[84:87]
  ds_read_b64_tr_b16 a[178:179], v191 offset:21984
  buffer_load_dwordx4 v17, s[12:15], s72 offen offset:0 lds
  s_waitcnt lgkmcnt(10)
  v_mfma_f32_16x16x32_bf16 v[88:91], a[144:147], a[188:191], v[88:91]
  ds_read_b64_tr_b16 a[180:181], v193 offset:20704
  v_mfma_f32_16x16x32_bf16 v[92:95], a[148:151], a[188:191], v[92:95]
  ds_read_b64_tr_b16 a[182:183], v193 offset:21984
  s_waitcnt lgkmcnt(10)
  v_mfma_f32_16x16x32_bf16 v[96:99], a[144:147], a[160:163], v[96:99]
  ds_read_b64_tr_b16 a[184:185], v185 offset:23104
  v_mfma_f32_16x16x32_bf16 v[100:103], a[148:151], a[160:163], v[100:103]
  ds_read_b64_tr_b16 a[186:187], v185 offset:24384
  s_waitcnt lgkmcnt(10)
  v_mfma_f32_16x16x32_bf16 v[104:107], a[144:147], a[164:167], v[104:107]
  ds_read_b64_tr_b16 a[188:189], v187 offset:23104
  v_mfma_f32_16x16x32_bf16 v[108:111], a[148:151], a[164:167], v[108:111]
  ds_read_b64_tr_b16 a[190:191], v187 offset:24384
  s_waitcnt lgkmcnt(10)
  v_mfma_f32_16x16x32_bf16 v[112:115], a[144:147], a[168:171], v[112:115]
  ds_read_b64_tr_b16 a[160:161], v189 offset:23104
  v_mfma_f32_16x16x32_bf16 v[116:119], a[148:151], a[168:171], v[116:119]
  ds_read_b64_tr_b16 a[162:163], v189 offset:24384
  s_waitcnt lgkmcnt(10)
  v_mfma_f32_16x16x32_bf16 v[120:123], a[144:147], a[172:175], v[120:123]
  ds_read_b64_tr_b16 a[164:165], v191 offset:23104
  v_mfma_f32_16x16x32_bf16 v[124:127], a[148:151], a[172:175], v[124:127]
  ds_read_b64_tr_b16 a[166:167], v191 offset:24384
  s_waitcnt lgkmcnt(10)
  v_mfma_f32_16x16x32_bf16 v[128:131], a[144:147], a[176:179], v[128:131]
  ds_read_b64_tr_b16 a[168:169], v193 offset:23104
  v_mfma_f32_16x16x32_bf16 v[132:135], a[148:151], a[176:179], v[132:135]
  ds_read_b64_tr_b16 a[170:171], v193 offset:24384
  s_waitcnt lgkmcnt(10)
  v_mfma_f32_16x16x32_bf16 v[136:139], a[144:147], a[180:183], v[136:139]
  ds_read_b64_tr_b16 a[172:173], v185 offset:23264
  v_mfma_f32_16x16x32_bf16 v[140:143], a[148:151], a[180:183], v[140:143]
  ds_read_b64_tr_b16 a[174:175], v185 offset:24544
  s_waitcnt lgkmcnt(10)
  v_mfma_f32_16x16x32_bf16 v[64:67], a[152:155], a[184:187], v[64:67]
  ds_read_b64_tr_b16 a[176:177], v187 offset:23264
  v_mfma_f32_16x16x32_bf16 v[68:71], a[156:159], a[184:187], v[68:71]
  ds_read_b64_tr_b16 a[178:179], v187 offset:24544
  s_waitcnt lgkmcnt(10)
  v_mfma_f32_16x16x32_bf16 v[72:75], a[152:155], a[188:191], v[72:75]
  ds_read_b64_tr_b16 a[180:181], v189 offset:23264
  v_mfma_f32_16x16x32_bf16 v[76:79], a[156:159], a[188:191], v[76:79]
  ds_read_b64_tr_b16 a[182:183], v189 offset:24544
  s_waitcnt lgkmcnt(10)
  v_mfma_f32_16x16x32_bf16 v[80:83], a[152:155], a[160:163], v[80:83]
  ds_read_b64_tr_b16 a[184:185], v191 offset:23264
  v_mfma_f32_16x16x32_bf16 v[84:87], a[156:159], a[160:163], v[84:87]
  ds_read_b64_tr_b16 a[186:187], v191 offset:24544
  s_waitcnt lgkmcnt(10)
  v_mfma_f32_16x16x32_bf16 v[88:91], a[152:155], a[164:167], v[88:91]
  ds_read_b64_tr_b16 a[188:189], v193 offset:23264
  v_mfma_f32_16x16x32_bf16 v[92:95], a[156:159], a[164:167], v[92:95]
  ds_read_b64_tr_b16 a[190:191], v193 offset:24544
  s_barrier
  s_add_u32 m0, s36, 61632
  s_waitcnt lgkmcnt(10)
  v_mfma_f32_16x16x32_bf16 v[96:99], a[152:155], a[168:171], v[96:99]
  v_mfma_f32_16x16x32_bf16 v[100:103], a[156:159], a[168:171], v[100:103]
  buffer_load_dwordx4 v13, s[12:15], s74 offen offset:0 lds
  s_waitcnt lgkmcnt(8)
  v_mfma_f32_16x16x32_bf16 v[104:107], a[152:155], a[172:175], v[104:107]
  v_mfma_f32_16x16x32_bf16 v[108:111], a[156:159], a[172:175], v[108:111]
  s_waitcnt lgkmcnt(6)
  v_mfma_f32_16x16x32_bf16 v[112:115], a[152:155], a[176:179], v[112:115]
  v_mfma_f32_16x16x32_bf16 v[116:119], a[156:159], a[176:179], v[116:119]
  buffer_load_dwordx4 v14, s[12:15], s74 offen offset:1024 lds
  s_waitcnt lgkmcnt(4)
  v_mfma_f32_16x16x32_bf16 v[120:123], a[152:155], a[180:183], v[120:123]
  v_mfma_f32_16x16x32_bf16 v[124:127], a[156:159], a[180:183], v[124:127]
  s_waitcnt lgkmcnt(2)
  v_mfma_f32_16x16x32_bf16 v[128:131], a[152:155], a[184:187], v[128:131]
  v_mfma_f32_16x16x32_bf16 v[132:135], a[156:159], a[184:187], v[132:135]
  buffer_load_dwordx4 v15, s[12:15], s74 offen offset:2048 lds
  s_waitcnt lgkmcnt(0)
  v_mfma_f32_16x16x32_bf16 v[136:139], a[152:155], a[188:191], v[136:139]
  v_mfma_f32_16x16x32_bf16 v[140:143], a[156:159], a[188:191], v[140:143]
  buffer_load_dwordx4 v16, s[12:15], s74 offen offset:3072 lds
  s_add_u32 m0, s36, 65728
  s_nop 0
  buffer_load_dwordx4 v17, s[12:15], s74 offen offset:0 lds
  s_mov_b32 exec_lo, 0xffffffff
  s_mov_b32 exec_hi, 0x3ffff
  global_load_dword v32, v35, s[16:17]
  s_mov_b64 exec, -1
  s_cmp_eq_u32 s28, 1
  s_cbranch_scc1 L_m1b
  v_cvt_pk_bf16_f32 v184, v64, v65
  v_cvt_pk_bf16_f32 v185, v66, v67
  v_cvt_pk_bf16_f32 v186, v68, v69
  v_cvt_pk_bf16_f32 v187, v70, v71
  ds_write_b64 v37, v[184:185] offset:0
  ds_write_b64 v37, v[186:187] offset:144
  v_cvt_pk_bf16_f32 v188, v72, v73
  v_cvt_pk_bf16_f32 v189, v74, v75
  v_cvt_pk_bf16_f32 v190, v76, v77
  v_cvt_pk_bf16_f32 v191, v78, v79
  ds_write_b64 v37, v[188:189] offset:1152
  ds_write_b64 v37, v[190:191] offset:1296
  v_cvt_pk_bf16_f32 v192, v80, v81
  v_cvt_pk_bf16_f32 v193, v82, v83
  v_cvt_pk_bf16_f32 v194, v84, v85
  v_cvt_pk_bf16_f32 v195, v86, v87
  ds_write_b64 v37, v[192:193] offset:2304
  ds_write_b64 v37, v[194:195] offset:2448
  v_cvt_pk_bf16_f32 v196, v88, v89
  v_cvt_pk_bf16_f32 v197, v90, v91
  v_cvt_pk_bf16_f32 v198, v92, v93
  v_cvt_pk_bf16_f32 v199, v94, v95
  ds_write_b64 v37, v[196:197] offset:3456
  ds_write_b64 v37, v[198:199] offset:3600
  v_cvt_pk_bf16_f32 v200, v96, v97
  v_cvt_pk_bf16_f32 v201, v98, v99
  v_cvt_pk_bf16_f32 v202, v100, v101
  v_cvt_pk_bf16_f32 v203, v102, v103
  ds_write_b64 v37, v[200:201] offset:4608
  ds_write_b64 v37, v[202:203] offset:4752
  v_cvt_pk_bf16_f32 v204, v104, v105
  v_cvt_pk_bf16_f32 v205, v106, v107
  v_cvt_pk_bf16_f32 v206, v108, v109
  v_cvt_pk_bf16_f32 v207, v110, v111
  ds_write_b64 v37, v[204:205] offset:23072
  ds_write_b64 v37, v[206:207] offset:23216
  v_cvt_pk_bf16_f32 v208, v112, v113
  v_cvt_pk_bf16_f32 v209, v114, v115
  v_cvt_pk_bf16_f32 v210, v116, v117
  v_cvt_pk_bf16_f32 v211, v118, v119
  ds_write_b64 v37, v[208:209] offset:24224
  ds_write_b64 v37, v[210:211] offset:24368
  v_cvt_pk_bf16_f32 v212, v120, v121
  v_cvt_pk_bf16_f32 v213, v122, v123
  v_cvt_pk_bf16_f32 v214, v124, v125
  v_cvt_pk_bf16_f32 v215, v126, v127
  ds_write_b64 v37, v[212:213] offset:25376
  ds_write_b64 v37, v[214:215] offset:25520
  v_cvt_pk_bf16_f32 v216, v128, v129
  v_cvt_pk_bf16_f32 v217, v130, v131
  v_cvt_pk_bf16_f32 v218, v132, v133
  v_cvt_pk_bf16_f32 v219, v134, v135
  ds_write_b64 v37, v[216:217] offset:26528
  ds_write_b64 v37, v[218:219] offset:26672
  v_cvt_pk_bf16_f32 v220, v136, v137
  v_cvt_pk_bf16_f32 v221, v138, v139
  v_cvt_pk_bf16_f32 v222, v140, v141
  v_cvt_pk_bf16_f32 v223, v142, v143
  ds_write_b64 v37, v[220:221] offset:27680
  ds_write_b64 v37, v[222:223] offset:27824
  s_cmp_lg_u32 s31, 3
  s_cbranch_scc1 L_nohalo
  s_add_u32 s3, s50, 2560
  v_subrev_u32 v6, 512, v46
  s_mov_b32 exec_lo, 0
  buffer_store_dwordx4 v[184:187], v6, s[24:27], s50 offen offset:0 sc1
  buffer_store_dwordx4 v[188:191], v6, s[24:27], s50 offen offset:512 sc1
  buffer_store_dwordx4 v[192:195], v6, s[24:27], s50 offen offset:1024 sc1
  buffer_store_dwordx4 v[196:199], v6, s[24:27], s50 offen offset:1536 sc1
  buffer_store_dwordx4 v[200:203], v6, s[24:27], s50 offen offset:2048 sc1
  buffer_store_dwordx4 v[204:207], v6, s[24:27], s3 offen offset:0 sc1
  buffer_store_dwordx4 v[208:211], v6, s[24:27], s3 offen offset:512 sc1
  buffer_store_dwordx4 v[212:215], v6, s[24:27], s3 offen offset:1024 sc1
  buffer_store_dwordx4 v[216:219], v6, s[24:27], s3 offen offset:1536 sc1
  buffer_store_dwordx4 v[220:223], v6, s[24:27], s3 offen offset:2048 sc1
  s_mov_b32 exec_lo, -1
  s_nop 0
L_nohalo:
  s_waitcnt lgkmcnt(0)
  s_branch L_m1done
L_m1b:
  s_mul_i32 s3, s31, 10304
  s_add_u32 s3, s3, 102720
  v_add_u32 v6, s3, v46
  v_cvt_pk_bf16_f32 v204, v104, v105
  v_cvt_pk_bf16_f32 v205, v106, v107
  v_cvt_pk_bf16_f32 v206, v108, v109
  v_cvt_pk_bf16_f32 v207, v110, v111
  ds_write_b128 v6, v[204:207] offset:5120
  v_cvt_pk_bf16_f32 v184, v112, v113
  v_cvt_pk_bf16_f32 v185, v114, v115
  v_cvt_pk_bf16_f32 v186, v116, v117
  v_cvt_pk_bf16_f32 v187, v118, v119
  ds_write_b128 v6, v[184:187] offset:6144
  v_cvt_pk_bf16_f32 v188, v120, v121
  v_cvt_pk_bf16_f32 v189, v122, v123
  v_cvt_pk_bf16_f32 v190, v124, v125
  v_cvt_pk_bf16_f32 v191, v126, v127
  ds_write_b128 v6, v[188:191] offset:7168
  v_cvt_pk_bf16_f32 v192, v128, v129
  v_cvt_pk_bf16_f32 v193, v130, v131
  v_cvt_pk_bf16_f32 v194, v132, v133
  v_cvt_pk_bf16_f32 v195, v134, v135
  ds_write_b128 v6, v[192:195] offset:8192
  v_cvt_pk_bf16_f32 v196, v136, v137
  v_cvt_pk_bf16_f32 v197, v138, v139
  v_cvt_pk_bf16_f32 v198, v140, v141
  v_cvt_pk_bf16_f32 v199, v142, v143
  ds_write_b128 v6, v[196:199] offset:9216
  v_mov_b32 v224, 0x3f803f80
  v_mov_b32 v225, 0x3f803f80
  v_mov_b32 v226, 0x3f803f80
  v_mov_b32 v227, 0x3f803f80
  v_mov_b32 v7, s3
  ds_write_b128 v7, v[224:227] offset:10240
  v_pk_mul_f32 v[208:209], v[64:65], s[82:83]
  v_pk_add_f32 v[64:65], v[64:65], 1.0 op_sel_hi:[1,0]
  v_pk_mul_f32 v[210:211], v[66:67], s[82:83]
  v_pk_add_f32 v[66:67], v[66:67], 1.0 op_sel_hi:[1,0]
  v_pk_mul_f32 v[212:213], v[68:69], s[82:83]
  v_pk_add_f32 v[68:69], v[68:69], 1.0 op_sel_hi:[1,0]
  v_pk_mul_f32 v[214:215], v[70:71], s[82:83]
  v_pk_add_f32 v[70:71], v[70:71], 1.0 op_sel_hi:[1,0]
  v_pk_mul_f32 v[216:217], v[72:73], s[82:83]
  v_pk_add_f32 v[72:73], v[72:73], 1.0 op_sel_hi:[1,0]
  v_pk_mul_f32 v[218:219], v[74:75], s[82:83]
  v_pk_add_f32 v[74:75], v[74:75], 1.0 op_sel_hi:[1,0]
  v_pk_mul_f32 v[220:221], v[76:77], s[82:83]
  v_pk_add_f32 v[76:77], v[76:77], 1.0 op_sel_hi:[1,0]
  v_pk_mul_f32 v[222:223], v[78:79], s[82:83]
  v_pk_add_f32 v[78:79], v[78:79], 1.0 op_sel_hi:[1,0]
  v_pk_mul_f32 v[224:225], v[80:81], s[82:83]
  v_pk_add_f32 v[80:81], v[80:81], 1.0 op_sel_hi:[1,0]
  v_pk_mul_f32 v[226:227], v[82:83], s[82:83]
  v_pk_add_f32 v[82:83], v[82:83], 1.0 op_sel_hi:[1,0]
  v_pk_mul_f32 v[228:229], v[84:85], s[82:83]
  v_pk_add_f32 v[84:85], v[84:85], 1.0 op_sel_hi:[1,0]
  v_pk_mul_f32 v[230:231], v[86:87], s[82:83]
  v_pk_add_f32 v[86:87], v[86:87], 1.0 op_sel_hi:[1,0]
  v_pk_mul_f32 v[232:233], v[88:89], s[82:83]
  v_pk_add_f32 v[88:89], v[88:89], 1.0 op_sel_hi:[1,0]
  v_pk_mul_f32 v[234:235], v[90:91], s[82:83]
  v_pk_add_f32 v[90:91], v[90:91], 1.0 op_sel_hi:[1,0]
  v_pk_mul_f32 v[236:237], v[92:93], s[82:83]
  v_pk_add_f32 v[92:93], v[92:93], 1.0 op_sel_hi:[1,0]
  v_pk_mul_f32 v[238:239], v[94:95], s[82:83]
  v_pk_add_f32 v[94:95], v[94:95], 1.0 op_sel_hi:[1,0]
  v_pk_mul_f32 v[240:241], v[96:97], s[82:83]
  v_pk_add_f32 v[96:97], v[96:97], 1.0 op_sel_hi:[1,0]
  v_pk_mul_f32 v[242:243], v[98:99], s[82:83]
  v_pk_add_f32 v[98:99], v[98:99], 1.0 op_sel_hi:[1,0]
  v_pk_mul_f32 v[244:245], v[100:101], s[82:83]
  v_pk_add_f32 v[100:101], v[100:101], 1.0 op_sel_hi:[1,0]
  v_pk_mul_f32 v[246:247], v[102:103], s[82:83]
  v_pk_add_f32 v[102:103], v[102:103], 1.0 op_sel_hi:[1,0]
  v_exp_f32_e64 v208, v208 clamp
  v_exp_f32_e64 v209, v209 clamp
  v_exp_f32_e64 v210, v210 clamp
  v_exp_f32_e64 v211, v211 clamp
  v_exp_f32_e64 v212, v212 clamp
  v_exp_f32_e64 v213, v213 clamp
  v_exp_f32_e64 v214, v214 clamp
  v_exp_f32_e64 v215, v215 clamp
  v_exp_f32_e64 v216, v216 clamp
  v_exp_f32_e64 v217, v217 clamp
  v_exp_f32_e64 v218, v218 clamp
  v_exp_f32_e64 v219, v219 clamp
  v_exp_f32_e64 v220, v220 clamp
  v_exp_f32_e64 v221, v221 clamp
  v_exp_f32_e64 v222, v222 clamp
  v_exp_f32_e64 v223, v223 clamp
  v_exp_f32_e64 v224, v224 clamp
  v_exp_f32_e64 v225, v225 clamp
  v_exp_f32_e64 v226, v226 clamp
  v_exp_f32_e64 v227, v227 clamp
  v_exp_f32_e64 v228, v228 clamp
  v_exp_f32_e64 v229, v229 clamp
  v_exp_f32_e64 v230, v230 clamp
  v_exp_f32_e64 v231, v231 clamp
  v_exp_f32_e64 v232, v232 clamp
  v_exp_f32_e64 v233, v233 clamp
  v_exp_f32_e64 v234, v234 clamp
  v_exp_f32_e64 v235, v235 clamp
  v_exp_f32_e64 v236, v236 clamp
  v_exp_f32_e64 v237, v237 clamp
  v_exp_f32_e64 v238, v238 clamp
  v_exp_f32_e64 v239, v239 clamp
  v_exp_f32_e64 v240, v240 clamp
  v_exp_f32_e64 v241, v241 clamp
  v_exp_f32_e64 v242, v242 clamp
  v_exp_f32_e64 v243, v243 clamp
  v_exp_f32_e64 v244, v244 clamp
  v_exp_f32_e64 v245, v245 clamp
  v_exp_f32_e64 v246, v246 clamp
  v_exp_f32_e64 v247, v247 clamp
  v_max_f32 v64, v64, v208
  v_max_f32 v65, v65, v209
  v_max_f32 v66, v66, v210
  v_max_f32 v67, v67, v211
  v_max_f32 v68, v68, v212
  v_max_f32 v69, v69, v213
  v_max_f32 v70, v70, v214
  v_max_f32 v71, v71, v215
  v_max_f32 v72, v72, v216
  v_max_f32 v73, v73, v217
  v_max_f32 v74, v74, v218
  v_max_f32 v75, v75, v219
  v_max_f32 v76, v76, v220
  v_max_f32 v77, v77, v221
  v_max_f32 v78, v78, v222
  v_max_f32 v79, v79, v223
  v_max_f32 v80, v80, v224
  v_max_f32 v81, v81, v225
  v_max_f32 v82, v82, v226
  v_max_f32 v83, v83, v227
  v_max_f32 v84, v84, v228
  v_max_f32 v85, v85, v229
  v_max_f32 v86, v86, v230
  v_max_f32 v87, v87, v231
  v_max_f32 v88, v88, v232
  v_max_f32 v89, v89, v233
  v_max_f32 v90, v90, v234
  v_max_f32 v91, v91, v235
  v_max_f32 v92, v92, v236
  v_max_f32 v93, v93, v237
  v_max_f32 v94, v94, v238
  v_max_f32 v95, v95, v239
  v_max_f32 v96, v96, v240
  v_max_f32 v97, v97, v241
  v_max_f32 v98, v98, v242
  v_max_f32 v99, v99, v243
  v_max_f32 v100, v100, v244
  v_max_f32 v101, v101, v245
  v_max_f32 v102, v102, v246
  v_max_f32 v103, v103, v247
  v_pk_add_f32 v[64:65], v[64:65], s[86:87]
  v_pk_add_f32 v[66:67], v[66:67], s[86:87]
  v_pk_add_f32 v[68:69], v[68:69], s[86:87]
  v_pk_add_f32 v[70:71], v[70:71], s[86:87]
  v_pk_add_f32 v[72:73], v[72:73], s[86:87]
  v_pk_add_f32 v[74:75], v[74:75], s[86:87]
  v_pk_add_f32 v[76:77], v[76:77], s[86:87]
  v_pk_add_f32 v[78:79], v[78:79], s[86:87]
  v_pk_add_f32 v[80:81], v[80:81], s[86:87]
  v_pk_add_f32 v[82:83], v[82:83], s[86:87]
  v_pk_add_f32 v[84:85], v[84:85], s[86:87]
  v_pk_add_f32 v[86:87], v[86:87], s[86:87]
  v_pk_add_f32 v[88:89], v[88:89], s[86:87]
  v_pk_add_f32 v[90:91], v[90:91], s[86:87]
  v_pk_add_f32 v[92:93], v[92:93], s[86:87]
  v_pk_add_f32 v[94:95], v[94:95], s[86:87]
  v_pk_add_f32 v[96:97], v[96:97], s[86:87]
  v_pk_add_f32 v[98:99], v[98:99], s[86:87]
  v_pk_add_f32 v[100:101], v[100:101], s[86:87]
  v_pk_add_f32 v[102:103], v[102:103], s[86:87]
  v_cvt_pk_bf16_f32 v184, v64, v65
  v_cvt_pk_bf16_f32 v185, v66, v67
  v_cvt_pk_bf16_f32 v186, v68, v69
  v_cvt_pk_bf16_f32 v187, v70, v71
  ds_write_b128 v6, v[184:187] offset:0
  v_cvt_pk_bf16_f32 v188, v72, v73
  v_cvt_pk_bf16_f32 v189, v74, v75
  v_cvt_pk_bf16_f32 v190, v76, v77
  v_cvt_pk_bf16_f32 v191, v78, v79
  ds_write_b128 v6, v[188:191] offset:1024
  v_cvt_pk_bf16_f32 v192, v80, v81
  v_cvt_pk_bf16_f32 v193, v82, v83
  v_cvt_pk_bf16_f32 v194, v84, v85
  v_cvt_pk_bf16_f32 v195, v86, v87
  ds_write_b128 v6, v[192:195] offset:2048
  v_cvt_pk_bf16_f32 v196, v88, v89
  v_cvt_pk_bf16_f32 v197, v90, v91
  v_cvt_pk_bf16_f32 v198, v92, v93
  v_cvt_pk_bf16_f32 v199, v94, v95
  ds_write_b128 v6, v[196:199] offset:3072
  v_cvt_pk_bf16_f32 v200, v96, v97
  v_cvt_pk_bf16_f32 v201, v98, v99
  v_cvt_pk_bf16_f32 v202, v100, v101
  v_cvt_pk_bf16_f32 v203, v102, v103
  ds_write_b128 v6, v[200:203] offset:4096
  s_lshl_b32 s3, s31, 10
  s_add_u32 s3, s3, 102720
  v_add_u32 v6, s3, v46
  s_lshl_b32 s3, s31, 6
  s_add_u32 s3, s3, 106816
  v_lshlrev_b32 v7, 8, v4
  v_lshl_add_u32 v7, v50, 4, v7
  v_add_u32 v7, s3, v7
  v_add_u32 v23, 5120, v7
  v_mov_b32 v24, 112960
  v_and_b32 v34, 4, v1
  v_cmp_eq_u32 vcc, 0, v34
  s_nop 1
  v_cndmask_b32 v23, v24, v23, vcc
  s_waitcnt lgkmcnt(0)
  s_barrier
  ds_read_b128 v[64:67], v6 offset:0
  ds_read_b128 v[68:71], v6 offset:5120
  ds_read_b128 v[72:75], v23 offset:0
  ds_read_b128 v[76:79], v7 offset:0
  ds_read_b128 v[80:83], v6 offset:10304
  ds_read_b128 v[84:87], v6 offset:15424
  ds_read_b128 v[88:91], v23 offset:10304
  ds_read_b128 v[92:95], v7 offset:10304
  ds_read_b128 v[96:99], v6 offset:20608
  ds_read_b128 v[100:103], v6 offset:25728
  ds_read_b128 v[104:107], v23 offset:20608
  ds_read_b128 v[108:111], v7 offset:20608
  ds_read_b128 v[112:115], v6 offset:30912
  ds_read_b128 v[116:119], v6 offset:36032
  ds_read_b128 v[120:123], v23 offset:30912
  ds_read_b128 v[124:127], v7 offset:30912
  s_waitcnt lgkmcnt(14)
  v_mfma_f32_16x16x32_bf16 v[184:187], v[64:67], v[68:71], 0
  s_waitcnt lgkmcnt(13)
  v_mfma_f32_16x16x32_bf16 v[188:191], v[64:67], v[72:75], 0
  s_waitcnt lgkmcnt(12)
  v_mfma_f32_16x16x32_bf16 v[192:195], v[76:79], v[68:71], 0
  v_mfma_f32_16x16x32_bf16 v[196:199], v[76:79], v[72:75], 0
  s_waitcnt lgkmcnt(10)
  v_mfma_f32_16x16x32_bf16 v[184:187], v[80:83], v[84:87], v[184:187]
  s_waitcnt lgkmcnt(9)
  v_mfma_f32_16x16x32_bf16 v[188:191], v[80:83], v[88:91], v[188:191]
  s_waitcnt lgkmcnt(8)
  v_mfma_f32_16x16x32_bf16 v[192:195], v[92:95], v[84:87], v[192:195]
  v_mfma_f32_16x16x32_bf16 v[196:199], v[92:95], v[88:91], v[196:199]
  s_waitcnt lgkmcnt(6)
  v_mfma_f32_16x16x32_bf16 v[184:187], v[96:99], v[100:103], v[184:187]
  s_waitcnt lgkmcnt(5)
  v_mfma_f32_16x16x32_bf16 v[188:191], v[96:99], v[104:107], v[188:191]
  s_waitcnt lgkmcnt(4)
  v_mfma_f32_16x16x32_bf16 v[192:195], v[108:111], v[100:103], v[192:195]
  v_mfma_f32_16x16x32_bf16 v[196:199], v[108:111], v[104:107], v[196:199]
  s_waitcnt lgkmcnt(2)
  v_mfma_f32_16x16x32_bf16 v[184:187], v[112:115], v[116:119], v[184:187]
  s_waitcnt lgkmcnt(1)
  v_mfma_f32_16x16x32_bf16 v[188:191], v[112:115], v[120:123], v[188:191]
  s_waitcnt lgkmcnt(0)
  v_mfma_f32_16x16x32_bf16 v[192:195], v[124:127], v[116:119], v[192:195]
  v_mfma_f32_16x16x32_bf16 v[196:199], v[124:127], v[120:123], v[196:199]
  s_waitcnt vmcnt(11)
  v_readfirstlane_b32 s3, v36
  s_nop 0
  s_cmp_eq_u32 s3, s39
  s_nop 3
  s_cbranch_scc1 L_zok
  s_mov_b32 s46, 16384
L_spin1:
  v_mov_b32 v7, 0
  buffer_load_dword v36, v7, s[24:27], s55 offen sc1
  s_waitcnt vmcnt(0)
  v_readfirstlane_b32 s3, v36
  s_nop 0
  s_cmp_eq_u32 s3, s39
  s_nop 2
  s_cbranch_scc1 L_spun1
  s_sleep 1
  s_sub_u32 s46, s46, 1
  s_cmp_lg_u32 s46, 0
  s_cbranch_scc1 L_spin1
L_spun1:
L_zok:
  s_mov_b32 s4, 0x00ffff00
  s_mov_b32 s5, 0
  s_mov_b32 s6, 0
  s_mov_b32 s7, 0xff00ff00
  buffer_atomic_add_f32 v184, v51, s[24:27], s54 offen offset:0 sc1
  buffer_atomic_add_f32 v185, v51, s[24:27], s54 offen offset:256 sc1
  buffer_atomic_add_f32 v186, v51, s[24:27], s54 offen offset:512 sc1
  buffer_atomic_add_f32 v187, v51, s[24:27], s54 offen offset:768 sc1
  v_cndmask_b32 v188, v188, v192, s[4:5]
  v_cndmask_b32 v188, v188, v196, s[6:7]
  v_cndmask_b32 v189, v189, v193, s[4:5]
  v_cndmask_b32 v189, v189, v197, s[6:7]
  v_cndmask_b32 v190, v190, v194, s[4:5]
  v_cndmask_b32 v190, v190, v198, s[6:7]
  v_cndmask_b32 v191, v191, v195, s[4:5]
  v_cndmask_b32 v191, v191, v199, s[6:7]
  buffer_atomic_add_f32 v188, v51, s[24:27], s54 offen offset:1024 sc1
  buffer_atomic_add_f32 v189, v51, s[24:27], s54 offen offset:1280 sc1
  buffer_atomic_add_f32 v190, v51, s[24:27], s54 offen offset:1536 sc1
  buffer_atomic_add_f32 v191, v51, s[24:27], s54 offen offset:1792 sc1
L_m1done:
  s_waitcnt vmcnt(17)
  s_barrier
  ds_read_b64_tr_b16 a[160:161], v26 offset:0
  ds_read_b64_tr_b16 a[162:163], v26 offset:1280
  ds_read_b64_tr_b16 a[164:165], v26 offset:8
  ds_read_b64_tr_b16 a[166:167], v26 offset:1288
  ds_read_b64_tr_b16 a[168:169], v26 offset:16
  ds_read_b64_tr_b16 a[170:171], v26 offset:1296
  ds_read_b64_tr_b16 a[172:173], v26 offset:24
  ds_read_b64_tr_b16 a[174:175], v26 offset:1304
  ds_read_b64_tr_b16 a[176:177], v26 offset:32
  ds_read_b64_tr_b16 a[178:179], v26 offset:1312
  ds_read_b64_tr_b16 a[180:181], v26 offset:2560
  ds_read_b64_tr_b16 a[182:183], v26 offset:3840
  s_waitcnt lgkmcnt(10)
  v_mfma_f32_16x16x32_bf16 v[144:147], a[160:163], a[0:3], 0
  ds_read_b64_tr_b16 a[184:185], v26 offset:2568
  v_mfma_f32_16x16x32_bf16 v[148:151], a[160:163], a[4:7], 0
  ds_read_b64_tr_b16 a[186:187], v26 offset:3848
  s_waitcnt lgkmcnt(10)
  v_mfma_f32_16x16x32_bf16 v[152:155], a[164:167], a[0:3], 0
  ds_read_b64_tr_b16 a[188:189], v26 offset:2576
  v_mfma_f32_16x16x32_bf16 v[156:159], a[164:167], a[4:7], 0
  ds_read_b64_tr_b16 a[190:191], v26 offset:3856
  s_waitcnt lgkmcnt(10)
  v_mfma_f32_16x16x32_bf16 v[160:163], a[168:171], a[0:3], 0
  ds_read_b64_tr_b16 a[160:161], v26 offset:2584
  v_mfma_f32_16x16x32_bf16 v[164:167], a[168:171], a[4:7], 0
  ds_read_b64_tr_b16 a[162:163], v26 offset:3864
  s_waitcnt lgkmcnt(10)
  v_mfma_f32_16x16x32_bf16 v[168:171], a[172:175], a[0:3], 0
  ds_read_b64_tr_b16 a[164:165], v26 offset:2592
  v_mfma_f32_16x16x32_bf16 v[172:175], a[172:175], a[4:7], 0
  ds_read_b64_tr_b16 a[166:167], v26 offset:3872
  s_waitcnt lgkmcnt(10)
  v_mfma_f32_16x16x32_bf16 v[176:179], a[176:179], a[0:3], 0
  ds_read_b64_tr_b16 a[168:169], v26 offset:160
  v_mfma_f32_16x16x32_bf16 v[180:183], a[176:179], a[4:7], 0
  ds_read_b64_tr_b16 a[170:171], v26 offset:1440
  s_waitcnt lgkmcnt(10)
  v_mfma_f32_16x16x32_bf16 v[144:147], a[180:183], a[8:11], v[144:147]
  ds_read_b64_tr_b16 a[172:173], v26 offset:168
  v_mfma_f32_16x16x32_bf16 v[148:151], a[180:183], a[12:15], v[148:151]
  ds_read_b64_tr_b16 a[174:175], v26 offset:1448
  s_waitcnt lgkmcnt(10)
  v_mfma_f32_16x16x32_bf16 v[152:155], a[184:187], a[8:11], v[152:155]
  ds_read_b64_tr_b16 a[176:177], v26 offset:176
  v_mfma_f32_16x16x32_bf16 v[156:159], a[184:187], a[12:15], v[156:159]
  ds_read_b64_tr_b16 a[178:179], v26 offset:1456
  s_waitcnt lgkmcnt(10)
  v_mfma_f32_16x16x32_bf16 v[160:163], a[188:191], a[8:11], v[160:163]
  ds_read_b64_tr_b16 a[180:181], v26 offset:184
  v_mfma_f32_16x16x32_bf16 v[164:167], a[188:191], a[12:15], v[164:167]
  ds_read_b64_tr_b16 a[182:183], v26 offset:1464
  s_waitcnt lgkmcnt(10)
  v_mfma_f32_16x16x32_bf16 v[168:171], a[160:163], a[8:11], v[168:171]
  ds_read_b64_tr_b16 a[184:185], v26 offset:192
  v_mfma_f32_16x16x32_bf16 v[172:175], a[160:163], a[12:15], v[172:175]
  ds_read_b64_tr_b16 a[186:187], v26 offset:1472
  s_waitcnt lgkmcnt(10)
  v_mfma_f32_16x16x32_bf16 v[176:179], a[164:167], a[8:11], v[176:179]
  ds_read_b64_tr_b16 a[188:189], v26 offset:2720
  v_mfma_f32_16x16x32_bf16 v[180:183], a[164:167], a[12:15], v[180:183]
  ds_read_b64_tr_b16 a[190:191], v26 offset:4000
  s_waitcnt lgkmcnt(10)
  v_mfma_f32_16x16x32_bf16 v[144:147], a[168:171], a[16:19], v[144:147]
  ds_read_b64_tr_b16 a[160:161], v26 offset:2728
  v_mfma_f32_16x16x32_bf16 v[148:151], a[168:171], a[20:23], v[148:151]
  ds_read_b64_tr_b16 a[162:163], v26 offset:4008
  s_waitcnt lgkmcnt(10)
  v_mfma_f32_16x16x32_bf16 v[152:155], a[172:175], a[16:19], v[152:155]
  ds_read_b64_tr_b16 a[164:165], v26 offset:2736
  v_mfma_f32_16x16x32_bf16 v[156:159], a[172:175], a[20:23], v[156:159]
  ds_read_b64_tr_b16 a[166:167], v26 offset:4016
  s_waitcnt lgkmcnt(10)
  v_mfma_f32_16x16x32_bf16 v[160:163], a[176:179], a[16:19], v[160:163]
  ds_read_b64_tr_b16 a[168:169], v26 offset:2744
  v_mfma_f32_16x16x32_bf16 v[164:167], a[176:179], a[20:23], v[164:167]
  ds_read_b64_tr_b16 a[170:171], v26 offset:4024
  s_waitcnt lgkmcnt(10)
  v_mfma_f32_16x16x32_bf16 v[168:171], a[180:183], a[16:19], v[168:171]
  ds_read_b64_tr_b16 a[172:173], v26 offset:2752
  v_mfma_f32_16x16x32_bf16 v[172:175], a[180:183], a[20:23], v[172:175]
  ds_read_b64_tr_b16 a[174:175], v26 offset:4032
  s_waitcnt vmcnt(12)
  s_barrier
  s_add_u32 m0, s36, 82176
  s_waitcnt lgkmcnt(10)
  v_mfma_f32_16x16x32_bf16 v[176:179], a[184:187], a[16:19], v[176:179]
  ds_read_b64_tr_b16 a[176:177], v26 offset:20544
  v_mfma_f32_16x16x32_bf16 v[180:183], a[184:187], a[20:23], v[180:183]
  ds_read_b64_tr_b16 a[178:179], v26 offset:21824
  buffer_load_dwordx4 v13, s[12:15], s76 offen offset:0 lds
  s_waitcnt lgkmcnt(10)
  v_mfma_f32_16x16x32_bf16 v[144:147], a[188:191], a[24:27], v[144:147]
  ds_read_b64_tr_b16 a[180:181], v26 offset:20552
  v_mfma_f32_16x16x32_bf16 v[148:151], a[188:191], a[28:31], v[148:151]
  ds_read_b64_tr_b16 a[182:183], v26 offset:21832
  s_waitcnt lgkmcnt(10)
  v_mfma_f32_16x16x32_bf16 v[152:155], a[160:163], a[24:27], v[152:155]
  ds_read_b64_tr_b16 a[184:185], v26 offset:20560
  v_mfma_f32_16x16x32_bf16 v[156:159], a[160:163], a[28:31], v[156:159]
  ds_read_b64_tr_b16 a[186:187], v26 offset:21840
  buffer_load_dwordx4 v14, s[12:15], s76 offen offset:1024 lds
  s_waitcnt lgkmcnt(10)
  v_mfma_f32_16x16x32_bf16 v[160:163], a[164:167], a[24:27], v[160:163]
  ds_read_b64_tr_b16 a[188:189], v26 offset:20568
  v_mfma_f32_16x16x32_bf16 v[164:167], a[164:167], a[28:31], v[164:167]
  ds_read_b64_tr_b16 a[190:191], v26 offset:21848
  s_waitcnt lgkmcnt(10)
  v_mfma_f32_16x16x32_bf16 v[168:171], a[168:171], a[24:27], v[168:171]
  ds_read_b64_tr_b16 a[160:161], v26 offset:20576
  v_mfma_f32_16x16x32_bf16 v[172:175], a[168:171], a[28:31], v[172:175]
  ds_read_b64_tr_b16 a[162:163], v26 offset:21856
  buffer_load_dwordx4 v15, s[12:15], s76 offen offset:2048 lds
  s_waitcnt lgkmcnt(10)
  v_mfma_f32_16x16x32_bf16 v[176:179], a[172:175], a[24:27], v[176:179]
  ds_read_b64_tr_b16 a[164:165], v26 offset:23104
  v_mfma_f32_16x16x32_bf16 v[180:183], a[172:175], a[28:31], v[180:183]
  ds_read_b64_tr_b16 a[166:167], v26 offset:24384
  s_waitcnt lgkmcnt(10)
  v_mfma_f32_16x16x32_bf16 v[144:147], a[176:179], a[32:35], v[144:147]
  ds_read_b64_tr_b16 a[168:169], v26 offset:23112
  v_mfma_f32_16x16x32_bf16 v[148:151], a[176:179], a[36:39], v[148:151]
  ds_read_b64_tr_b16 a[170:171], v26 offset:24392
  buffer_load_dwordx4 v16, s[12:15], s76 offen offset:3072 lds
  s_add_u32 m0, s36, 86272
  s_waitcnt lgkmcnt(10)
  v_mfma_f32_16x16x32_bf16 v[152:155], a[180:183], a[32:35], v[152:155]
  ds_read_b64_tr_b16 a[172:173], v26 offset:23120
  v_mfma_f32_16x16x32_bf16 v[156:159], a[180:183], a[36:39], v[156:159]
  ds_read_b64_tr_b16 a[174:175], v26 offset:24400
  s_waitcnt lgkmcnt(10)
  v_mfma_f32_16x16x32_bf16 v[160:163], a[184:187], a[32:35], v[160:163]
  ds_read_b64_tr_b16 a[176:177], v26 offset:23128
  v_mfma_f32_16x16x32_bf16 v[164:167], a[184:187], a[36:39], v[164:167]
  ds_read_b64_tr_b16 a[178:179], v26 offset:24408
  buffer_load_dwordx4 v17, s[12:15], s76 offen offset:0 lds
  s_waitcnt lgkmcnt(10)
  v_mfma_f32_16x16x32_bf16 v[168:171], a[188:191], a[32:35], v[168:171]
  ds_read_b64_tr_b16 a[180:181], v26 offset:23136
  v_mfma_f32_16x16x32_bf16 v[172:175], a[188:191], a[36:39], v[172:175]
  ds_read_b64_tr_b16 a[182:183], v26 offset:24416
  s_waitcnt lgkmcnt(10)
  v_mfma_f32_16x16x32_bf16 v[176:179], a[160:163], a[32:35], v[176:179]
  ds_read_b64_tr_b16 a[184:185], v26 offset:20704
  v_mfma_f32_16x16x32_bf16 v[180:183], a[160:163], a[36:39], v[180:183]
  ds_read_b64_tr_b16 a[186:187], v26 offset:21984
  s_waitcnt lgkmcnt(10)
  v_mfma_f32_16x16x32_bf16 v[144:147], a[164:167], a[40:43], v[144:147]
  ds_read_b64_tr_b16 a[188:189], v26 offset:20712
  v_mfma_f32_16x16x32_bf16 v[148:151], a[164:167], a[44:47], v[148:151]
  ds_read_b64_tr_b16 a[190:191], v26 offset:21992
  s_waitcnt lgkmcnt(10)
  v_mfma_f32_16x16x32_bf16 v[152:155], a[168:171], a[40:43], v[152:155]
  ds_read_b64_tr_b16 a[160:161], v26 offset:20720
  v_mfma_f32_16x16x32_bf16 v[156:159], a[168:171], a[44:47], v[156:159]
  ds_read_b64_tr_b16 a[162:163], v26 offset:22000
  s_waitcnt lgkmcnt(10)
  v_mfma_f32_16x16x32_bf16 v[160:163], a[172:175], a[40:43], v[160:163]
  ds_read_b64_tr_b16 a[164:165], v26 offset:20728
  v_mfma_f32_16x16x32_bf16 v[164:167], a[172:175], a[44:47], v[164:167]
  ds_read_b64_tr_b16 a[166:167], v26 offset:22008
  s_waitcnt lgkmcnt(10)
  v_mfma_f32_16x16x32_bf16 v[168:171], a[176:179], a[40:43], v[168:171]
  ds_read_b64_tr_b16 a[168:169], v26 offset:20736
  v_mfma_f32_16x16x32_bf16 v[172:175], a[176:179], a[44:47], v[172:175]
  ds_read_b64_tr_b16 a[170:171], v26 offset:22016
  s_waitcnt lgkmcnt(10)
  v_mfma_f32_16x16x32_bf16 v[176:179], a[180:183], a[40:43], v[176:179]
  ds_read_b64_tr_b16 a[172:173], v26 offset:23264
  v_mfma_f32_16x16x32_bf16 v[180:183], a[180:183], a[44:47], v[180:183]
  ds_read_b64_tr_b16 a[174:175], v26 offset:24544
  s_waitcnt lgkmcnt(10)
  v_mfma_f32_16x16x32_bf16 v[144:147], a[184:187], a[48:51], v[144:147]
  ds_read_b64_tr_b16 a[176:177], v26 offset:23272
  v_mfma_f32_16x16x32_bf16 v[148:151], a[184:187], a[52:55], v[148:151]
  ds_read_b64_tr_b16 a[178:179], v26 offset:24552
  s_waitcnt lgkmcnt(10)
  v_mfma_f32_16x16x32_bf16 v[152:155], a[188:191], a[48:51], v[152:155]
  ds_read_b64_tr_b16 a[180:181], v26 offset:23280
  v_mfma_f32_16x16x32_bf16 v[156:159], a[188:191], a[52:55], v[156:159]
  ds_read_b64_tr_b16 a[182:183], v26 offset:24560
  s_waitcnt lgkmcnt(10)
  v_mfma_f32_16x16x32_bf16 v[160:163], a[160:163], a[48:51], v[160:163]
  ds_read_b64_tr_b16 a[184:185], v26 offset:23288
  v_mfma_f32_16x16x32_bf16 v[164:167], a[160:163], a[52:55], v[164:167]
  ds_read_b64_tr_b16 a[186:187], v26 offset:24568
  s_waitcnt lgkmcnt(10)
  v_mfma_f32_16x16x32_bf16 v[168:171], a[164:167], a[48:51], v[168:171]
  ds_read_b64_tr_b16 a[188:189], v26 offset:23296
  v_mfma_f32_16x16x32_bf16 v[172:175], a[164:167], a[52:55], v[172:175]
  ds_read_b64_tr_b16 a[190:191], v26 offset:24576
  s_waitcnt vmcnt(11)
  s_waitcnt vmcnt(5)
  s_cmp_eq_u32 s51, 0
  s_nop 3
  s_cbranch_scc1 L_nof1
  v_mov_b32 v6, s39
  v_mov_b32 v7, 0
  s_mov_b64 exec, 1
  buffer_store_dword v6, v7, s[24:27], s47 offen sc1
  s_mov_b64 exec, -1
L_nof1:
  s_barrier
  s_mov_b32 m0, s45
  s_waitcnt lgkmcnt(10)
  v_mfma_f32_16x16x32_bf16 v[176:179], a[168:171], a[48:51], v[176:179]
  ds_read_b64_tr_b16 a[160:161], v26 offset:41088
  v_mfma_f32_16x16x32_bf16 v[180:183], a[168:171], a[52:55], v[180:183]
  ds_read_b64_tr_b16 a[162:163], v26 offset:42368
  s_add_u32 s37, s35, 0
  buffer_load_dwordx4 v18, s[16:19], s37 offen offset:0 lds
  s_waitcnt lgkmcnt(10)
  v_mfma_f32_16x16x32_bf16 v[144:147], a[172:175], a[56:59], v[144:147]
  ds_read_b64_tr_b16 a[164:165], v26 offset:41096
  v_mfma_f32_16x16x32_bf16 v[148:151], a[172:175], a[60:63], v[148:151]
  ds_read_b64_tr_b16 a[166:167], v26 offset:42376
  s_waitcnt lgkmcnt(10)
  v_mfma_f32_16x16x32_bf16 v[152:155], a[176:179], a[56:59], v[152:155]
  ds_read_b64_tr_b16 a[168:169], v26 offset:41104
  v_mfma_f32_16x16x32_bf16 v[156:159], a[176:179], a[60:63], v[156:159]
  ds_read_b64_tr_b16 a[170:171], v26 offset:42384
  buffer_load_dwordx4 v19, s[16:19], s37 offen offset:1024 lds
  s_waitcnt lgkmcnt(10)
  v_mfma_f32_16x16x32_bf16 v[160:163], a[180:183], a[56:59], v[160:163]
  ds_read_b64_tr_b16 a[172:173], v26 offset:41112
  v_mfma_f32_16x16x32_bf16 v[164:167], a[180:183], a[60:63], v[164:167]
  ds_read_b64_tr_b16 a[174:175], v26 offset:42392
  s_waitcnt lgkmcnt(10)
  v_mfma_f32_16x16x32_bf16 v[168:171], a[184:187], a[56:59], v[168:171]
  ds_read_b64_tr_b16 a[176:177], v26 offset:41120
  v_mfma_f32_16x16x32_bf16 v[172:175], a[184:187], a[60:63], v[172:175]
  ds_read_b64_tr_b16 a[178:179], v26 offset:42400
  buffer_load_dwordx4 v20, s[16:19], s37 offen offset:2048 lds
  s_waitcnt lgkmcnt(10)
  v_mfma_f32_16x16x32_bf16 v[176:179], a[188:191], a[56:59], v[176:179]
  ds_read_b64_tr_b16 a[180:181], v26 offset:43648
  v_mfma_f32_16x16x32_bf16 v[180:183], a[188:191], a[60:63], v[180:183]
  ds_read_b64_tr_b16 a[182:183], v26 offset:44928
  s_waitcnt lgkmcnt(10)
  v_mfma_f32_16x16x32_bf16 v[144:147], a[160:163], a[64:67], v[144:147]
  ds_read_b64_tr_b16 a[184:185], v26 offset:43656
  v_mfma_f32_16x16x32_bf16 v[148:151], a[160:163], a[68:71], v[148:151]
  ds_read_b64_tr_b16 a[186:187], v26 offset:44936
  buffer_load_dwordx4 v21, s[16:19], s37 offen offset:3072 lds
  s_add_u32 m0, s45, 4096
  s_waitcnt lgkmcnt(10)
  v_mfma_f32_16x16x32_bf16 v[152:155], a[164:167], a[64:67], v[152:155]
  ds_read_b64_tr_b16 a[188:189], v26 offset:43664
  v_mfma_f32_16x16x32_bf16 v[156:159], a[164:167], a[68:71], v[156:159]
  ds_read_b64_tr_b16 a[190:191], v26 offset:44944
  v_min_u32 v7, 28, v51
  buffer_load_dword v33, v7, s[24:27], s33 offen sc1
  s_waitcnt lgkmcnt(10)
  v_mfma_f32_16x16x32_bf16 v[160:163], a[168:171], a[64:67], v[160:163]
  ds_read_b64_tr_b16 a[160:161], v26 offset:43672
  v_mfma_f32_16x16x32_bf16 v[164:167], a[168:171], a[68:71], v[164:167]
  ds_read_b64_tr_b16 a[162:163], v26 offset:44952
  buffer_load_dwordx4 v22, s[16:19], s37 offen offset:0 lds
  s_waitcnt lgkmcnt(10)
  v_mfma_f32_16x16x32_bf16 v[168:171], a[172:175], a[64:67], v[168:171]
  ds_read_b64_tr_b16 a[164:165], v26 offset:43680
  v_mfma_f32_16x16x32_bf16 v[172:175], a[172:175], a[68:71], v[172:175]
  ds_read_b64_tr_b16 a[166:167], v26 offset:44960
  s_waitcnt lgkmcnt(10)
  v_mfma_f32_16x16x32_bf16 v[176:179], a[176:179], a[64:67], v[176:179]
  ds_read_b64_tr_b16 a[168:169], v26 offset:41248
  v_mfma_f32_16x16x32_bf16 v[180:183], a[176:179], a[68:71], v[180:183]
  ds_read_b64_tr_b16 a[170:171], v26 offset:42528
  s_waitcnt lgkmcnt(10)
  v_mfma_f32_16x16x32_bf16 v[144:147], a[180:183], a[72:75], v[144:147]
  ds_read_b64_tr_b16 a[172:173], v26 offset:41256
  v_mfma_f32_16x16x32_bf16 v[148:151], a[180:183], a[76:79], v[148:151]
  ds_read_b64_tr_b16 a[174:175], v26 offset:42536
  s_waitcnt lgkmcnt(10)
  v_mfma_f32_16x16x32_bf16 v[152:155], a[184:187], a[72:75], v[152:155]
  ds_read_b64_tr_b16 a[176:177], v26 offset:41264
  v_mfma_f32_16x16x32_bf16 v[156:159], a[184:187], a[76:79], v[156:159]
  ds_read_b64_tr_b16 a[178:179], v26 offset:42544
  s_waitcnt lgkmcnt(10)
  v_mfma_f32_16x16x32_bf16 v[160:163], a[188:191], a[72:75], v[160:163]
  ds_read_b64_tr_b16 a[180:181], v26 offset:41272
  v_mfma_f32_16x16x32_bf16 v[164:167], a[188:191], a[76:79], v[164:167]
  ds_read_b64_tr_b16 a[182:183], v26 offset:42552
  s_waitcnt lgkmcnt(10)
  v_mfma_f32_16x16x32_bf16 v[168:171], a[160:163], a[72:75], v[168:171]
  ds_read_b64_tr_b16 a[184:185], v26 offset:41280
  v_mfma_f32_16x16x32_bf16 v[172:175], a[160:163], a[76:79], v[172:175]
  ds_read_b64_tr_b16 a[186:187], v26 offset:42560
  s_waitcnt lgkmcnt(10)
  v_mfma_f32_16x16x32_bf16 v[176:179], a[164:167], a[72:75], v[176:179]
  ds_read_b64_tr_b16 a[188:189], v26 offset:43808
  v_mfma_f32_16x16x32_bf16 v[180:183], a[164:167], a[76:79], v[180:183]
  ds_read_b64_tr_b16 a[190:191], v26 offset:45088
  s_waitcnt lgkmcnt(10)
  v_mfma_f32_16x16x32_bf16 v[144:147], a[168:171], a[80:83], v[144:147]
  ds_read_b64_tr_b16 a[160:161], v26 offset:43816
  v_mfma_f32_16x16x32_bf16 v[148:151], a[168:171], a[84:87], v[148:151]
  ds_read_b64_tr_b16 a[162:163], v26 offset:45096
  s_waitcnt lgkmcnt(10)
  v_mfma_f32_16x16x32_bf16 v[152:155], a[172:175], a[80:83], v[152:155]
  ds_read_b64_tr_b16 a[164:165], v26 offset:43824
  v_mfma_f32_16x16x32_bf16 v[156:159], a[172:175], a[84:87], v[156:159]
  ds_read_b64_tr_b16 a[166:167], v26 offset:45104
  s_waitcnt lgkmcnt(10)
  v_mfma_f32_16x16x32_bf16 v[160:163], a[176:179], a[80:83], v[160:163]
  ds_read_b64_tr_b16 a[168:169], v26 offset:43832
  v_mfma_f32_16x16x32_bf16 v[164:167], a[176:179], a[84:87], v[164:167]
  ds_read_b64_tr_b16 a[170:171], v26 offset:45112
  s_waitcnt lgkmcnt(10)
  v_mfma_f32_16x16x32_bf16 v[168:171], a[180:183], a[80:83], v[168:171]
  ds_read_b64_tr_b16 a[172:173], v26 offset:43840
  v_mfma_f32_16x16x32_bf16 v[172:175], a[180:183], a[84:87], v[172:175]
  ds_read_b64_tr_b16 a[174:175], v26 offset:45120
  s_barrier
  s_add_u32 m0, s45, 20480
  s_waitcnt lgkmcnt(10)
  v_mfma_f32_16x16x32_bf16 v[176:179], a[184:187], a[80:83], v[176:179]
  ds_read_b64_tr_b16 a[176:177], v27 offset:0
  v_mfma_f32_16x16x32_bf16 v[180:183], a[184:187], a[84:87], v[180:183]
  ds_read_b64_tr_b16 a[178:179], v27 offset:1280
  s_add_u32 s37, s35, 163840
  buffer_load_dwordx4 v18, s[16:19], s37 offen offset:0 lds
  s_waitcnt lgkmcnt(10)
  v_mfma_f32_16x16x32_bf16 v[144:147], a[188:191], a[88:91], v[144:147]
  ds_read_b64_tr_b16 a[180:181], v27 offset:8
  v_mfma_f32_16x16x32_bf16 v[148:151], a[188:191], a[92:95], v[148:151]
  ds_read_b64_tr_b16 a[182:183], v27 offset:1288
  s_waitcnt lgkmcnt(10)
  v_mfma_f32_16x16x32_bf16 v[152:155], a[160:163], a[88:91], v[152:155]
  ds_read_b64_tr_b16 a[184:185], v27 offset:16
  v_mfma_f32_16x16x32_bf16 v[156:159], a[160:163], a[92:95], v[156:159]
  ds_read_b64_tr_b16 a[186:187], v27 offset:1296
  buffer_load_dwordx4 v19, s[16:19], s37 offen offset:1024 lds
  s_waitcnt lgkmcnt(10)
  v_mfma_f32_16x16x32_bf16 v[160:163], a[164:167], a[88:91], v[160:163]
  ds_read_b64_tr_b16 a[188:189], v27 offset:24
  v_mfma_f32_16x16x32_bf16 v[164:167], a[164:167], a[92:95], v[164:167]
  ds_read_b64_tr_b16 a[190:191], v27 offset:1304
  s_waitcnt lgkmcnt(10)
  v_mfma_f32_16x16x32_bf16 v[168:171], a[168:171], a[88:91], v[168:171]
  ds_read_b64_tr_b16 a[160:161], v27 offset:32
  v_mfma_f32_16x16x32_bf16 v[172:175], a[168:171], a[92:95], v[172:175]
  ds_read_b64_tr_b16 a[162:163], v27 offset:1312
  buffer_load_dwordx4 v20, s[16:19], s37 offen offset:2048 lds
  s_waitcnt lgkmcnt(10)
  v_mfma_f32_16x16x32_bf16 v[176:179], a[172:175], a[88:91], v[176:179]
  ds_read_b64_tr_b16 a[164:165], v27 offset:2560
  v_mfma_f32_16x16x32_bf16 v[180:183], a[172:175], a[92:95], v[180:183]
  ds_read_b64_tr_b16 a[166:167], v27 offset:3840
  s_waitcnt lgkmcnt(10)
  v_mfma_f32_16x16x32_bf16 v[144:147], a[176:179], a[96:99], v[144:147]
  ds_read_b64_tr_b16 a[168:169], v27 offset:2568
  v_mfma_f32_16x16x32_bf16 v[148:151], a[176:179], a[100:103], v[148:151]
  ds_read_b64_tr_b16 a[170:171], v27 offset:3848
  buffer_load_dwordx4 v21, s[16:19], s37 offen offset:3072 lds
  s_add_u32 m0, s45, 24576
  s_waitcnt lgkmcnt(10)
  v_mfma_f32_16x16x32_bf16 v[152:155], a[180:183], a[96:99], v[152:155]
  ds_read_b64_tr_b16 a[172:173], v27 offset:2576
  v_mfma_f32_16x16x32_bf16 v[156:159], a[180:183], a[100:103], v[156:159]
  ds_read_b64_tr_b16 a[174:175], v27 offset:3856
  s_waitcnt lgkmcnt(10)
  v_mfma_f32_16x16x32_bf16 v[160:163], a[184:187], a[96:99], v[160:163]
  ds_read_b64_tr_b16 a[176:177], v27 offset:2584
  v_mfma_f32_16x16x32_bf16 v[164:167], a[184:187], a[100:103], v[164:167]
  ds_read_b64_tr_b16 a[178:179], v27 offset:3864
  buffer_load_dwordx4 v22, s[16:19], s37 offen offset:0 lds
  s_waitcnt lgkmcnt(10)
  v_mfma_f32_16x16x32_bf16 v[168:171], a[188:191], a[96:99], v[168:171]
  ds_read_b64_tr_b16 a[180:181], v27 offset:2592
  v_mfma_f32_16x16x32_bf16 v[172:175], a[188:191], a[100:103], v[172:175]
  ds_read_b64_tr_b16 a[182:183], v27 offset:3872
  s_waitcnt lgkmcnt(10)
  v_mfma_f32_16x16x32_bf16 v[176:179], a[160:163], a[96:99], v[176:179]
  ds_read_b64_tr_b16 a[184:185], v27 offset:160
  v_mfma_f32_16x16x32_bf16 v[180:183], a[160:163], a[100:103], v[180:183]
  ds_read_b64_tr_b16 a[186:187], v27 offset:1440
  s_waitcnt lgkmcnt(10)
  v_mfma_f32_16x16x32_bf16 v[144:147], a[164:167], a[104:107], v[144:147]
  ds_read_b64_tr_b16 a[188:189], v27 offset:168
  v_mfma_f32_16x16x32_bf16 v[148:151], a[164:167], a[108:111], v[148:151]
  ds_read_b64_tr_b16 a[190:191], v27 offset:1448
  s_waitcnt lgkmcnt(10)
  v_mfma_f32_16x16x32_bf16 v[152:155], a[168:171], a[104:107], v[152:155]
  ds_read_b64_tr_b16 a[160:161], v27 offset:176
  v_mfma_f32_16x16x32_bf16 v[156:159], a[168:171], a[108:111], v[156:159]
  ds_read_b64_tr_b16 a[162:163], v27 offset:1456
  s_waitcnt lgkmcnt(10)
  v_mfma_f32_16x16x32_bf16 v[160:163], a[172:175], a[104:107], v[160:163]
  ds_read_b64_tr_b16 a[164:165], v27 offset:184
  v_mfma_f32_16x16x32_bf16 v[164:167], a[172:175], a[108:111], v[164:167]
  ds_read_b64_tr_b16 a[166:167], v27 offset:1464
  s_waitcnt lgkmcnt(10)
  v_mfma_f32_16x16x32_bf16 v[168:171], a[176:179], a[104:107], v[168:171]
  ds_read_b64_tr_b16 a[168:169], v27 offset:192
  v_mfma_f32_16x16x32_bf16 v[172:175], a[176:179], a[108:111], v[172:175]
  ds_read_b64_tr_b16 a[170:171], v27 offset:1472
  s_waitcnt lgkmcnt(10)
  v_mfma_f32_16x16x32_bf16 v[176:179], a[180:183], a[104:107], v[176:179]
  ds_read_b64_tr_b16 a[172:173], v27 offset:2720
  v_mfma_f32_16x16x32_bf16 v[180:183], a[180:183], a[108:111], v[180:183]
  ds_read_b64_tr_b16 a[174:175], v27 offset:4000
  s_waitcnt lgkmcnt(10)
  v_mfma_f32_16x16x32_bf16 v[144:147], a[184:187], a[112:115], v[144:147]
  ds_read_b64_tr_b16 a[176:177], v27 offset:2728
  v_mfma_f32_16x16x32_bf16 v[148:151], a[184:187], a[116:119], v[148:151]
  ds_read_b64_tr_b16 a[178:179], v27 offset:4008
  s_waitcnt lgkmcnt(10)
  v_mfma_f32_16x16x32_bf16 v[152:155], a[188:191], a[112:115], v[152:155]
  ds_read_b64_tr_b16 a[180:181], v27 offset:2736
  v_mfma_f32_16x16x32_bf16 v[156:159], a[188:191], a[116:119], v[156:159]
  ds_read_b64_tr_b16 a[182:183], v27 offset:4016
  s_waitcnt lgkmcnt(10)
  v_mfma_f32_16x16x32_bf16 v[160:163], a[160:163], a[112:115], v[160:163]
  ds_read_b64_tr_b16 a[184:185], v27 offset:2744
  v_mfma_f32_16x16x32_bf16 v[164:167], a[160:163], a[116:119], v[164:167]
  ds_read_b64_tr_b16 a[186:187], v27 offset:4024
  s_waitcnt lgkmcnt(10)
  v_mfma_f32_16x16x32_bf16 v[168:171], a[164:167], a[112:115], v[168:171]
  ds_read_b64_tr_b16 a[188:189], v27 offset:2752
  v_mfma_f32_16x16x32_bf16 v[172:175], a[164:167], a[116:119], v[172:175]
  ds_read_b64_tr_b16 a[190:191], v27 offset:4032
  s_waitcnt vmcnt(11)
  s_barrier
  s_add_u32 m0, s45, 40960
  s_waitcnt lgkmcnt(10)
  v_mfma_f32_16x16x32_bf16 v[176:179], a[168:171], a[112:115], v[176:179]
  ds_read_b64_tr_b16 a[160:161], v27 offset:20544
  v_mfma_f32_16x16x32_bf16 v[180:183], a[168:171], a[116:119], v[180:183]
  ds_read_b64_tr_b16 a[162:163], v27 offset:21824
  s_add_u32 s37, s35, 327680
  buffer_load_dwordx4 v18, s[16:19], s37 offen offset:0 lds
  s_waitcnt lgkmcnt(10)
  v_mfma_f32_16x16x32_bf16 v[144:147], a[172:175], a[120:123], v[144:147]
  ds_read_b64_tr_b16 a[164:165], v27 offset:20552
  v_mfma_f32_16x16x32_bf16 v[148:151], a[172:175], a[124:127], v[148:151]
  ds_read_b64_tr_b16 a[166:167], v27 offset:21832
  s_waitcnt lgkmcnt(10)
  v_mfma_f32_16x16x32_bf16 v[152:155], a[176:179], a[120:123], v[152:155]
  ds_read_b64_tr_b16 a[168:169], v27 offset:20560
  v_mfma_f32_16x16x32_bf16 v[156:159], a[176:179], a[124:127], v[156:159]
  ds_read_b64_tr_b16 a[170:171], v27 offset:21840
  buffer_load_dwordx4 v19, s[16:19], s37 offen offset:1024 lds
  s_waitcnt lgkmcnt(10)
  v_mfma_f32_16x16x32_bf16 v[160:163], a[180:183], a[120:123], v[160:163]
  ds_read_b64_tr_b16 a[172:173], v27 offset:20568
  v_mfma_f32_16x16x32_bf16 v[164:167], a[180:183], a[124:127], v[164:167]
  ds_read_b64_tr_b16 a[174:175], v27 offset:21848
  s_waitcnt lgkmcnt(10)
  v_mfma_f32_16x16x32_bf16 v[168:171], a[184:187], a[120:123], v[168:171]
  ds_read_b64_tr_b16 a[176:177], v27 offset:20576
  v_mfma_f32_16x16x32_bf16 v[172:175], a[184:187], a[124:127], v[172:175]
  ds_read_b64_tr_b16 a[178:179], v27 offset:21856
  buffer_load_dwordx4 v20, s[16:19], s37 offen offset:2048 lds
  s_waitcnt lgkmcnt(10)
  v_mfma_f32_16x16x32_bf16 v[176:179], a[188:191], a[120:123], v[176:179]
  ds_read_b64_tr_b16 a[180:181], v27 offset:23104
  v_mfma_f32_16x16x32_bf16 v[180:183], a[188:191], a[124:127], v[180:183]
  ds_read_b64_tr_b16 a[182:183], v27 offset:24384
  s_waitcnt lgkmcnt(10)
  v_mfma_f32_16x16x32_bf16 v[144:147], a[160:163], a[128:131], v[144:147]
  ds_read_b64_tr_b16 a[184:185], v27 offset:23112
  v_mfma_f32_16x16x32_bf16 v[148:151], a[160:163], a[132:135], v[148:151]
  ds_read_b64_tr_b16 a[186:187], v27 offset:24392
  buffer_load_dwordx4 v21, s[16:19], s37 offen offset:3072 lds
  s_add_u32 m0, s45, 45056
  s_waitcnt lgkmcnt(10)
  v_mfma_f32_16x16x32_bf16 v[152:155], a[164:167], a[128:131], v[152:155]
  ds_read_b64_tr_b16 a[188:189], v27 offset:23120
  v_mfma_f32_16x16x32_bf16 v[156:159], a[164:167], a[132:135], v[156:159]
  ds_read_b64_tr_b16 a[190:191], v27 offset:24400
  s_waitcnt lgkmcnt(10)
  v_mfma_f32_16x16x32_bf16 v[160:163], a[168:171], a[128:131], v[160:163]
  ds_read_b64_tr_b16 a[160:161], v27 offset:23128
  v_mfma_f32_16x16x32_bf16 v[164:167], a[168:171], a[132:135], v[164:167]
  ds_read_b64_tr_b16 a[162:163], v27 offset:24408
  buffer_load_dwordx4 v22, s[16:19], s37 offen offset:0 lds
  s_waitcnt lgkmcnt(10)
  v_mfma_f32_16x16x32_bf16 v[168:171], a[172:175], a[128:131], v[168:171]
  ds_read_b64_tr_b16 a[164:165], v27 offset:23136
  v_mfma_f32_16x16x32_bf16 v[172:175], a[172:175], a[132:135], v[172:175]
  ds_read_b64_tr_b16 a[166:167], v27 offset:24416
  buffer_load_dword v36, v25, s[24:27], s57 offen sc1
  s_waitcnt lgkmcnt(10)
  v_mfma_f32_16x16x32_bf16 v[176:179], a[176:179], a[128:131], v[176:179]
  ds_read_b64_tr_b16 a[168:169], v27 offset:20704
  v_mfma_f32_16x16x32_bf16 v[180:183], a[176:179], a[132:135], v[180:183]
  ds_read_b64_tr_b16 a[170:171], v27 offset:21984
  s_waitcnt lgkmcnt(10)
  v_mfma_f32_16x16x32_bf16 v[144:147], a[180:183], a[136:139], v[144:147]
  ds_read_b64_tr_b16 a[172:173], v27 offset:20712
  v_mfma_f32_16x16x32_bf16 v[148:151], a[180:183], a[140:143], v[148:151]
  ds_read_b64_tr_b16 a[174:175], v27 offset:21992
  s_waitcnt lgkmcnt(10)
  v_mfma_f32_16x16x32_bf16 v[152:155], a[184:187], a[136:139], v[152:155]
  ds_read_b64_tr_b16 a[176:177], v27 offset:20720
  v_mfma_f32_16x16x32_bf16 v[156:159], a[184:187], a[140:143], v[156:159]
  ds_read_b64_tr_b16 a[178:179], v27 offset:22000
  s_waitcnt lgkmcnt(10)
  v_mfma_f32_16x16x32_bf16 v[160:163], a[188:191], a[136:139], v[160:163]
  ds_read_b64_tr_b16 a[180:181], v27 offset:20728
  v_mfma_f32_16x16x32_bf16 v[164:167], a[188:191], a[140:143], v[164:167]
  ds_read_b64_tr_b16 a[182:183], v27 offset:22008
  s_waitcnt lgkmcnt(10)
  v_mfma_f32_16x16x32_bf16 v[168:171], a[160:163], a[136:139], v[168:171]
  ds_read_b64_tr_b16 a[184:185], v27 offset:20736
  v_mfma_f32_16x16x32_bf16 v[172:175], a[160:163], a[140:143], v[172:175]
  ds_read_b64_tr_b16 a[186:187], v27 offset:22016
  s_waitcnt lgkmcnt(10)
  v_mfma_f32_16x16x32_bf16 v[176:179], a[164:167], a[136:139], v[176:179]
  ds_read_b64_tr_b16 a[188:189], v27 offset:23264
  v_mfma_f32_16x16x32_bf16 v[180:183], a[164:167], a[140:143], v[180:183]
  ds_read_b64_tr_b16 a[190:191], v27 offset:24544
  s_waitcnt lgkmcnt(10)
  v_mfma_f32_16x16x32_bf16 v[144:147], a[168:171], a[144:147], v[144:147]
  ds_read_b64_tr_b16 a[160:161], v27 offset:23272
  v_mfma_f32_16x16x32_bf16 v[148:151], a[168:171], a[148:151], v[148:151]
  ds_read_b64_tr_b16 a[162:163], v27 offset:24552
  s_waitcnt lgkmcnt(10)
  v_mfma_f32_16x16x32_bf16 v[152:155], a[172:175], a[144:147], v[152:155]
  ds_read_b64_tr_b16 a[164:165], v27 offset:23280
  v_mfma_f32_16x16x32_bf16 v[156:159], a[172:175], a[148:151], v[156:159]
  ds_read_b64_tr_b16 a[166:167], v27 offset:24560
  s_waitcnt lgkmcnt(10)
  v_mfma_f32_16x16x32_bf16 v[160:163], a[176:179], a[144:147], v[160:163]
  ds_read_b64_tr_b16 a[168:169], v27 offset:23288
  v_mfma_f32_16x16x32_bf16 v[164:167], a[176:179], a[148:151], v[164:167]
  ds_read_b64_tr_b16 a[170:171], v27 offset:24568
  s_waitcnt lgkmcnt(10)
  v_mfma_f32_16x16x32_bf16 v[168:171], a[180:183], a[144:147], v[168:171]
  ds_read_b64_tr_b16 a[172:173], v27 offset:23296
  v_mfma_f32_16x16x32_bf16 v[172:175], a[180:183], a[148:151], v[172:175]
  ds_read_b64_tr_b16 a[174:175], v27 offset:24576
  s_barrier
  s_add_u32 m0, s45, 61440
  s_waitcnt lgkmcnt(10)
  v_mfma_f32_16x16x32_bf16 v[176:179], a[184:187], a[144:147], v[176:179]
  v_mfma_f32_16x16x32_bf16 v[180:183], a[184:187], a[148:151], v[180:183]
  s_add_u32 s37, s35, 491520
  buffer_load_dwordx4 v18, s[16:19], s37 offen offset:0 lds
  s_waitcnt lgkmcnt(8)
  v_mfma_f32_16x16x32_bf16 v[144:147], a[188:191], a[152:155], v[144:147]
  v_mfma_f32_16x16x32_bf16 v[148:151], a[188:191], a[156:159], v[148:151]
  s_waitcnt lgkmcnt(6)
  v_mfma_f32_16x16x32_bf16 v[152:155], a[160:163], a[152:155], v[152:155]
  v_mfma_f32_16x16x32_bf16 v[156:159], a[160:163], a[156:159], v[156:159]
  buffer_load_dwordx4 v19, s[16:19], s37 offen offset:1024 lds
  s_waitcnt lgkmcnt(4)
  v_mfma_f32_16x16x32_bf16 v[160:163], a[164:167], a[152:155], v[160:163]
  v_mfma_f32_16x16x32_bf16 v[164:167], a[164:167], a[156:159], v[164:167]
  s_waitcnt lgkmcnt(2)
  v_mfma_f32_16x16x32_bf16 v[168:171], a[168:171], a[152:155], v[168:171]
  v_mfma_f32_16x16x32_bf16 v[172:175], a[168:171], a[156:159], v[172:175]
  buffer_load_dwordx4 v20, s[16:19], s37 offen offset:2048 lds
  s_waitcnt lgkmcnt(0)
  v_mfma_f32_16x16x32_bf16 v[176:179], a[172:175], a[152:155], v[176:179]
  v_mfma_f32_16x16x32_bf16 v[180:183], a[172:175], a[156:159], v[180:183]
  buffer_load_dwordx4 v21, s[16:19], s37 offen offset:3072 lds
  s_add_u32 m0, s45, 65536
  s_nop 0
  buffer_load_dwordx4 v22, s[16:19], s37 offen offset:0 lds
  s_barrier
  s_add_u32 m0, s45, 81920
  s_add_u32 s37, s35, 655360
  buffer_load_dwordx4 v18, s[16:19], s37 offen offset:0 lds
  buffer_load_dwordx4 v19, s[16:19], s37 offen offset:1024 lds
  buffer_load_dwordx4 v20, s[16:19], s37 offen offset:2048 lds
  buffer_load_dwordx4 v21, s[16:19], s37 offen offset:3072 lds
  s_add_u32 m0, s45, 86016
  s_nop 0
  buffer_load_dwordx4 v22, s[16:19], s37 offen offset:0 lds
  s_waitcnt vmcnt(22)
  v_and_b32 v6, 0xffffffe1, v33
  v_cmp_eq_u32 vcc, s39, v6
  s_nop 0
  s_cmp_eq_u64 vcc, -1
  s_nop 2
  s_cbranch_scc1 L_xgok
  s_mov_b32 s46, 16384
L_spin2:
  v_min_u32 v7, 28, v51
  buffer_load_dword v33, v7, s[24:27], s33 offen sc1
  s_waitcnt vmcnt(0)
  v_and_b32 v6, 0xffffffe1, v33
  v_cmp_eq_u32 vcc, s39, v6
  s_nop 0
  s_cmp_eq_u64 vcc, -1
  s_nop 2
  s_cbranch_scc1 L_spun2
  s_sleep 1
  s_sub_u32 s46, s46, 1
  s_cmp_lg_u32 s46, 0
  s_cbranch_scc1 L_spin2
L_spun2:
L_xgok:
  v_cmp_eq_u32 vcc, s38, v33
  s_nop 0
  s_cmp_eq_u64 vcc, -1
  s_cselect_b32 s80, 1, 0
  s_cselect_b32 s8, s20, s24
  s_cselect_b32 s9, s21, s25
  s_mov_b32 s10, 5242880
  s_cmp_eq_u32 s81, 0
  s_cbranch_scc1 L_midok
  s_waitcnt vmcnt(10)
  v_cmp_eq_u32 vcc, s39, v36
  s_nop 0
  s_cmp_eq_u64 vcc, -1
  s_nop 2
  s_cbranch_scc1 L_midgo
  s_mov_b32 s46, 16384
L_spin3:
  buffer_load_dword v36, v25, s[24:27], s57 offen sc1
  s_waitcnt vmcnt(0)
  v_cmp_eq_u32 vcc, s39, v36
  s_nop 0
  s_cmp_eq_u64 vcc, -1
  s_nop 2
  s_cbranch_scc1 L_spun3
  s_sleep 1
  s_sub_u32 s46, s46, 1
  s_cmp_lg_u32 s46, 0
  s_cbranch_scc1 L_spin3
L_spun3:
L_midgo:
  s_cmp_eq_u32 s28, 1
  s_cbranch_scc1 L_mlb1
  s_sub_u32 s3, s50, 40960
  s_add_u32 s4, s3, 2560
  v_subrev_u32 v6, 512, v46
  s_mov_b32 exec_lo, 0
  s_nop 0
  buffer_load_dwordx4 v[64:67], v6, s[24:27], s3 offen offset:0 sc1
  buffer_load_dwordx4 v[68:71], v6, s[24:27], s3 offen offset:512 sc1
  buffer_load_dwordx4 v[72:75], v6, s[24:27], s3 offen offset:1024 sc1
  buffer_load_dwordx4 v[76:79], v6, s[24:27], s3 offen offset:1536 sc1
  buffer_load_dwordx4 v[80:83], v6, s[24:27], s3 offen offset:2048 sc1
  buffer_load_dwordx4 v[84:87], v6, s[24:27], s4 offen offset:0 sc1
  buffer_load_dwordx4 v[88:91], v6, s[24:27], s4 offen offset:512 sc1
  buffer_load_dwordx4 v[92:95], v6, s[24:27], s4 offen offset:1024 sc1
  buffer_load_dwordx4 v[96:99], v6, s[24:27], s4 offen offset:1536 sc1
  buffer_load_dwordx4 v[100:103], v6, s[24:27], s4 offen offset:2048 sc1
  s_mov_b32 exec_lo, -1
  s_branch L_mld1
L_mlb1:
  buffer_load_dword v64, v51, s[24:27], s54 offen offset:0 sc1
  buffer_load_dword v65, v51, s[24:27], s54 offen offset:256 sc1
  buffer_load_dword v66, v51, s[24:27], s54 offen offset:512 sc1
  buffer_load_dword v67, v51, s[24:27], s54 offen offset:768 sc1
  buffer_load_dword v68, v51, s[24:27], s54 offen offset:1024 sc1
  buffer_load_dword v69, v51, s[24:27], s54 offen offset:1280 sc1
  buffer_load_dword v70, v51, s[24:27], s54 offen offset:1536 sc1
  buffer_load_dword v71, v51, s[24:27], s54 offen offset:1792 sc1
L_mld1:
  s_mov_b32 s81, 0
L_midok:
  s_cmp_eq_u32 s28, 1
  s_cbranch_scc1 L_m2b
  s_or_b32 s3, s29, s31
  s_cmp_lg_u32 s3, 0
  s_cbranch_scc1 L_halo1
  v_mov_b32 v64, 0
  v_mov_b32 v65, 0
  v_mov_b32 v66, 0
  v_mov_b32 v67, 0
  v_mov_b32 v68, 0
  v_mov_b32 v69, 0
  v_mov_b32 v70, 0
  v_mov_b32 v71, 0
  v_mov_b32 v72, 0
  v_mov_b32 v73, 0
  v_mov_b32 v74, 0
  v_mov_b32 v75, 0
  v_mov_b32 v76, 0
  v_mov_b32 v77, 0
  v_mov_b32 v78, 0
  v_mov_b32 v79, 0
  v_mov_b32 v80, 0
  v_mov_b32 v81, 0
  v_mov_b32 v82, 0
  v_mov_b32 v83, 0
  v_mov_b32 v84, 0
  v_mov_b32 v85, 0
  v_mov_b32 v86, 0
  v_mov_b32 v87, 0
  v_mov_b32 v88, 0
  v_mov_b32 v89, 0
  v_mov_b32 v90, 0
  v_mov_b32 v91, 0
  v_mov_b32 v92, 0
  v_mov_b32 v93, 0
  v_mov_b32 v94, 0
  v_mov_b32 v95, 0
  v_mov_b32 v96, 0
  v_mov_b32 v97, 0
  v_mov_b32 v98, 0
  v_mov_b32 v99, 0
  v_mov_b32 v100, 0
  v_mov_b32 v101, 0
  v_mov_b32 v102, 0
  v_mov_b32 v103, 0
  s_nop 1
L_halo1:
  v_cvt_pk_bf16_f32 v184, v144, v145
  v_cvt_pk_bf16_f32 v185, v146, v147
  v_cvt_pk_bf16_f32 v194, v148, v149
  v_cvt_pk_bf16_f32 v195, v150, v151
  v_cvt_pk_bf16_f32 v186, v152, v153
  v_cvt_pk_bf16_f32 v187, v154, v155
  v_cvt_pk_bf16_f32 v196, v156, v157
  v_cvt_pk_bf16_f32 v197, v158, v159
  v_cvt_pk_bf16_f32 v188, v160, v161
  v_cvt_pk_bf16_f32 v189, v162, v163
  v_cvt_pk_bf16_f32 v198, v164, v165
  v_cvt_pk_bf16_f32 v199, v166, v167
  v_cvt_pk_bf16_f32 v190, v168, v169
  v_cvt_pk_bf16_f32 v191, v170, v171
  v_cvt_pk_bf16_f32 v200, v172, v173
  v_cvt_pk_bf16_f32 v201, v174, v175
  v_cvt_pk_bf16_f32 v192, v176, v177
  v_cvt_pk_bf16_f32 v193, v178, v179
  v_cvt_pk_bf16_f32 v202, v180, v181
  v_cvt_pk_bf16_f32 v203, v182, v183
  s_cmp_eq_u32 s3, 0
  s_cselect_b32 s4, 0, 64
  v_mov_b32 v6, 0xf149f2ca
  v_lshlrev_b32 v7, 2, v49
  v_add_u32 v7, s4, v7
  v_cmp_le_u32 vcc, 0, v50
  s_nop 1
  v_cndmask_b32 v52, v6, 0, vcc
  v_cmp_le_u32 vcc, 1, v50
  s_nop 1
  v_cndmask_b32 v53, v6, 0, vcc
  v_cmp_le_u32 vcc, 2, v50
  s_nop 1
  v_cndmask_b32 v54, v6, 0, vcc
  v_cmp_le_u32 vcc, 3, v50
  s_nop 1
  v_cndmask_b32 v55, v6, 0, vcc
  v_cmp_le_u32 vcc, 4, v7
  s_nop 1
  v_cndmask_b32 v56, v6, 0, vcc
  v_cmp_le_u32 vcc, 3, v7
  s_nop 1
  v_cndmask_b32 v57, v6, 0, vcc
  v_cmp_le_u32 vcc, 2, v7
  s_nop 1
  v_cndmask_b32 v58, v6, 0, vcc
  v_cmp_le_u32 vcc, 1, v7
  s_nop 1
  v_cndmask_b32 v59, v6, 0, vcc
  v_cmp_le_u32 vcc, 8, v7
  s_nop 1
  v_cndmask_b32 v60, v6, 0, vcc
  v_cmp_gt_u32 vcc, 0, v50
  s_nop 1
  v_cndmask_b32 v60, v6, v60, vcc
  v_cmp_le_u32 vcc, 7, v7
  s_nop 1
  v_cndmask_b32 v61, v6, 0, vcc
  v_cmp_gt_u32 vcc, 1, v50
  s_nop 1
  v_cndmask_b32 v61, v6, v61, vcc
  v_cmp_le_u32 vcc, 6, v7
  s_nop 1
  v_cndmask_b32 v62, v6, 0, vcc
  v_cmp_gt_u32 vcc, 2, v50
  s_nop 1
  v_cndmask_b32 v62, v6, v62, vcc
  v_cmp_le_u32 vcc, 5, v7
  s_nop 1
  v_cndmask_b32 v63, v6, 0, vcc
  v_cmp_gt_u32 vcc, 3, v50
  s_nop 1
  v_cndmask_b32 v63, v6, v63, vcc
  v_mov_b32 v240, 0x3f803f80
  v_mov_b32 v241, 0x3f803f80
  s_mov_b32 s4, 0x3ea52b5c
  s_cmp_lg_u32 s31, 0
  s_cbranch_scc1 L_halodone
  v_subrev_u32 v23, 32, v37
  s_waitcnt vmcnt(0)
  s_mov_b32 exec_lo, 0
  ds_write_b64 v23, v[64:65] offset:0
  ds_write_b64 v23, v[66:67] offset:144
  ds_write_b64 v23, v[68:69] offset:1152
  ds_write_b64 v23, v[70:71] offset:1296
  ds_write_b64 v23, v[72:73] offset:2304
  ds_write_b64 v23, v[74:75] offset:2448
  ds_write_b64 v23, v[76:77] offset:3456
  ds_write_b64 v23, v[78:79] offset:3600
  ds_write_b64 v23, v[80:81] offset:4608
  ds_write_b64 v23, v[82:83] offset:4752
  ds_write_b64 v23, v[84:85] offset:23072
  ds_write_b64 v23, v[86:87] offset:23216
  ds_write_b64 v23, v[88:89] offset:24224
  ds_write_b64 v23, v[90:91] offset:24368
  ds_write_b64 v23, v[92:93] offset:25376
  ds_write_b64 v23, v[94:95] offset:25520
  ds_write_b64 v23, v[96:97] offset:26528
  ds_write_b64 v23, v[98:99] offset:26672
  ds_write_b64 v23, v[100:101] offset:27680
  ds_write_b64 v23, v[102:103] offset:27824
  s_mov_b32 exec_lo, -1
  s_waitcnt lgkmcnt(0)
L_halodone:
  s_mov_b32 exec_lo, 0xffffffff
  s_mov_b32 exec_hi, 0xff
  buffer_load_dword v32, v252, s[8:11], s44 offen sc1
  s_mov_b64 exec, 1
  buffer_load_dword v32, v51, s[24:27], s49 offen sc1
  s_mov_b64 exec, -1
  ds_read_b64_tr_b16 a[0:1], v38 offset:16
  ds_read_b64_tr_b16 a[10:11], v38 offset:8
  ds_read_b64_tr_b16 a[20:21], v38 offset:0
  ds_read_b64_tr_b16 a[30:31], v38 offset:160
  ds_read_b64_tr_b16 a[40:41], v38 offset:152
  ds_read_b64_tr_b16 a[50:51], v38 offset:144
  ds_read_b64_tr_b16 a[2:3], v38 offset:1168
  ds_read_b64_tr_b16 a[12:13], v38 offset:1160
  ds_read_b64_tr_b16 a[22:23], v38 offset:1152
  ds_read_b64_tr_b16 a[32:33], v38 offset:1312
  ds_read_b64_tr_b16 a[42:43], v38 offset:1304
  ds_read_b64_tr_b16 a[52:53], v38 offset:1296
  ds_read_b64_tr_b16 a[4:5], v38 offset:2320
  ds_read_b64_tr_b16 a[14:15], v38 offset:2312
  ds_read_b64_tr_b16 a[24:25], v38 offset:2304
  ds_read_b64_tr_b16 a[34:35], v38 offset:2464
  ds_read_b64_tr_b16 a[44:45], v38 offset:2456
  ds_read_b64_tr_b16 a[54:55], v38 offset:2448
  ds_read_b64_tr_b16 a[6:7], v38 offset:3472
  ds_read_b64_tr_b16 a[16:17], v38 offset:3464
  ds_read_b64_tr_b16 a[26:27], v38 offset:3456
  ds_read_b64_tr_b16 a[36:37], v38 offset:3616
  ds_read_b64_tr_b16 a[46:47], v38 offset:3608
  ds_read_b64_tr_b16 a[56:57], v38 offset:3600
  ds_read_b64_tr_b16 a[8:9], v38 offset:4624
  ds_read_b64_tr_b16 a[18:19], v38 offset:4616
  ds_read_b64_tr_b16 a[28:29], v38 offset:4608
  ds_read_b64_tr_b16 a[38:39], v38 offset:4768
  ds_read_b64_tr_b16 a[48:49], v38 offset:4760
  ds_read_b64_tr_b16 a[58:59], v38 offset:4752
  ds_read_b64 a[60:61], v39 offset:16
  ds_read_b64 a[70:71], v39 offset:8
  ds_read_b64 a[80:81], v39 offset:0
  ds_read_b64 a[90:91], v39 offset:160
  ds_read_b64 a[100:101], v39 offset:152
  ds_read_b64 a[110:111], v39 offset:144
  ds_read_b64 a[62:63], v39 offset:1168
  ds_read_b64 a[72:73], v39 offset:1160
  ds_read_b64 a[82:83], v39 offset:1152
  ds_read_b64 a[92:93], v39 offset:1312
  ds_read_b64 a[102:103], v39 offset:1304
  ds_read_b64 a[112:113], v39 offset:1296
  ds_read_b64 a[64:65], v39 offset:2320
  ds_read_b64 a[74:75], v39 offset:2312
  ds_read_b64 a[84:85], v39 offset:2304
  ds_read_b64 a[94:95], v39 offset:2464
  ds_read_b64 a[104:105], v39 offset:2456
  ds_read_b64 a[114:115], v39 offset:2448
  ds_read_b64 a[66:67], v39 offset:3472
  ds_read_b64 a[76:77], v39 offset:3464
  ds_read_b64 a[86:87], v39 offset:3456
  ds_read_b64 a[96:97], v39 offset:3616
  ds_read_b64 a[106:107], v39 offset:3608
  ds_read_b64 a[116:117], v39 offset:3600
  ds_read_b64 a[68:69], v39 offset:4624
  ds_read_b64 a[78:79], v39 offset:4616
  ds_read_b64 a[88:89], v39 offset:4608
  ds_read_b64 a[98:99], v39 offset:4768
  ds_read_b64 a[108:109], v39 offset:4760
  ds_read_b64 a[118:119], v39 offset:4752
  s_waitcnt lgkmcnt(15)
  v_mfma_f32_4x4x4_16b_bf16 v[204:207], a[0:1], v[184:185], v[52:55]
  v_mfma_f32_4x4x4_16b_bf16 v[208:211], a[10:11], v[184:185], v[56:59]
  v_mfma_f32_4x4x4_16b_bf16 v[212:215], a[20:21], v[184:185], v[60:63]
  v_mfma_f32_4x4x4_16b_bf16 v[216:219], a[30:31], v[194:195], v[52:55]
  v_mfma_f32_4x4x4_16b_bf16 v[220:223], a[40:41], v[194:195], v[56:59]
  v_mfma_f32_4x4x4_16b_bf16 v[224:227], a[50:51], v[194:195], v[60:63]
  v_mfma_f32_4x4x4_16b_bf16 v[204:207], a[2:3], v[186:187], v[204:207]
  v_mfma_f32_4x4x4_16b_bf16 v[208:211], a[12:13], v[186:187], v[208:211]
  v_mfma_f32_4x4x4_16b_bf16 v[212:215], a[22:23], v[186:187], v[212:215]
  v_mfma_f32_4x4x4_16b_bf16 v[216:219], a[32:33], v[196:197], v[216:219]
  v_mfma_f32_4x4x4_16b_bf16 v[220:223], a[42:43], v[196:197], v[220:223]
  v_mfma_f32_4x4x4_16b_bf16 v[224:227], a[52:53], v[196:197], v[224:227]
  v_mfma_f32_4x4x4_16b_bf16 v[204:207], a[4:5], v[188:189], v[204:207]
  v_mfma_f32_4x4x4_16b_bf16 v[208:211], a[14:15], v[188:189], v[208:211]
  v_mfma_f32_4x4x4_16b_bf16 v[212:215], a[24:25], v[188:189], v[212:215]
  v_mfma_f32_4x4x4_16b_bf16 v[216:219], a[34:35], v[198:199], v[216:219]
  v_mfma_f32_4x4x4_16b_bf16 v[220:223], a[44:45], v[198:199], v[220:223]
  v_mfma_f32_4x4x4_16b_bf16 v[224:227], a[54:55], v[198:199], v[224:227]
  v_mfma_f32_4x4x4_16b_bf16 v[204:207], a[6:7], v[190:191], v[204:207]
  v_mfma_f32_4x4x4_16b_bf16 v[208:211], a[16:17], v[190:191], v[208:211]
  v_mfma_f32_4x4x4_16b_bf16 v[212:215], a[26:27], v[190:191], v[212:215]
  v_mfma_f32_4x4x4_16b_bf16 v[216:219], a[36:37], v[200:201], v[216:219]
  v_mfma_f32_4x4x4_16b_bf16 v[220:223], a[46:47], v[200:201], v[220:223]
  v_mfma_f32_4x4x4_16b_bf16 v[224:227], a[56:57], v[200:201], v[224:227]
  v_mfma_f32_4x4x4_16b_bf16 v[204:207], a[8:9], v[192:193], v[204:207]
  v_mfma_f32_4x4x4_16b_bf16 v[208:211], a[18:19], v[192:193], v[208:211]
  v_mfma_f32_4x4x4_16b_bf16 v[212:215], a[28:29], v[192:193], v[212:215]
  v_mfma_f32_4x4x4_16b_bf16 v[216:219], a[38:39], v[202:203], v[216:219]
  v_mfma_f32_4x4x4_16b_bf16 v[220:223], a[48:49], v[202:203], v[220:223]
  v_mfma_f32_4x4x4_16b_bf16 v[224:227], a[58:59], v[202:203], v[224:227]
  v_max3_f32 v242, v204, v205, v206
  v_max3_f32 v243, v207, v208, v209
  v_max3_f32 v244, v210, v211, v212
  v_max3_f32 v245, v213, v214, v215
  v_max3_f32 v242, v242, v243, v244
  v_max_f32 v242, v242, v245
  v_mul_f32 v242, s4, v242
  v_max3_f32 v246, v216, v217, v218
  v_max3_f32 v247, v219, v220, v221
  v_max3_f32 v248, v222, v223, v224
  v_max3_f32 v249, v225, v226, v227
  v_max3_f32 v246, v246, v247, v248
  v_max_f32 v246, v246, v249
  v_mul_f32 v246, s4, v246
  v_fma_f32 v204, v204, s4, -v242
  v_fma_f32 v205, v205, s4, -v242
  v_fma_f32 v206, v206, s4, -v242
  v_fma_f32 v207, v207, s4, -v242
  v_fma_f32 v208, v208, s4, -v242
  v_fma_f32 v209, v209, s4, -v242
  v_fma_f32 v210, v210, s4, -v242
  v_fma_f32 v211, v211, s4, -v242
  v_fma_f32 v212, v212, s4, -v242
  v_fma_f32 v213, v213, s4, -v242
  v_fma_f32 v214, v214, s4, -v242
  v_fma_f32 v215, v215, s4, -v242
  v_exp_f32 v204, v204
  v_exp_f32 v205, v205
  v_exp_f32 v206, v206
  v_exp_f32 v207, v207
  v_exp_f32 v208, v208
  v_exp_f32 v209, v209
  v_exp_f32 v210, v210
  v_exp_f32 v211, v211
  v_exp_f32 v212, v212
  v_exp_f32 v213, v213
  v_exp_f32 v214, v214
  v_exp_f32 v215, v215
  v_fma_f32 v216, v216, s4, -v246
  v_fma_f32 v217, v217, s4, -v246
  v_fma_f32 v218, v218, s4, -v246
  v_fma_f32 v219, v219, s4, -v246
  v_fma_f32 v220, v220, s4, -v246
  v_fma_f32 v221, v221, s4, -v246
  v_fma_f32 v222, v222, s4, -v246
  v_fma_f32 v223, v223, s4, -v246
  v_fma_f32 v224, v224, s4, -v246
  v_fma_f32 v225, v225, s4, -v246
  v_fma_f32 v226, v226, s4, -v246
  v_fma_f32 v227, v227, s4, -v246
  v_exp_f32 v216, v216
  v_exp_f32 v217, v217
  v_exp_f32 v218, v218
  v_exp_f32 v219, v219
  v_exp_f32 v220, v220
  v_exp_f32 v221, v221
  v_exp_f32 v222, v222
  v_exp_f32 v223, v223
  v_exp_f32 v224, v224
  v_exp_f32 v225, v225
  v_exp_f32 v226, v226
  v_exp_f32 v227, v227
  v_cvt_pk_bf16_f32 v228, v204, v205
  v_cvt_pk_bf16_f32 v229, v206, v207
  v_cvt_pk_bf16_f32 v230, v208, v209
  v_cvt_pk_bf16_f32 v231, v210, v211
  v_cvt_pk_bf16_f32 v232, v212, v213
  v_cvt_pk_bf16_f32 v233, v214, v215
  v_cvt_pk_bf16_f32 v234, v216, v217
  v_cvt_pk_bf16_f32 v235, v218, v219
  v_cvt_pk_bf16_f32 v236, v220, v221
  v_cvt_pk_bf16_f32 v237, v222, v223
  v_cvt_pk_bf16_f32 v238, v224, v225
  v_cvt_pk_bf16_f32 v239, v226, v227
  v_mfma_f32_4x4x4_16b_bf16 v[64:67], a[60:61], v[228:229], 0
  v_mfma_f32_4x4x4_16b_bf16 v[68:71], a[62:63], v[228:229], 0
  v_mfma_f32_4x4x4_16b_bf16 v[72:75], a[64:65], v[228:229], 0
  s_waitcnt lgkmcnt(11)
  v_mfma_f32_4x4x4_16b_bf16 v[76:79], a[66:67], v[228:229], 0
  s_waitcnt lgkmcnt(5)
  v_mfma_f32_4x4x4_16b_bf16 v[80:83], a[68:69], v[228:229], 0
  v_mfma_f32_4x4x4_16b_bf16 v[84:87], v[240:241], v[228:229], 0
  v_mfma_f32_4x4x4_16b_bf16 v[88:91], a[90:91], v[234:235], 0
  v_mfma_f32_4x4x4_16b_bf16 v[92:95], a[92:93], v[234:235], 0
  v_mfma_f32_4x4x4_16b_bf16 v[96:99], a[94:95], v[234:235], 0
  v_mfma_f32_4x4x4_16b_bf16 v[100:103], a[96:97], v[234:235], 0
  s_waitcnt lgkmcnt(2)
  v_mfma_f32_4x4x4_16b_bf16 v[104:107], a[98:99], v[234:235], 0
  v_mfma_f32_4x4x4_16b_bf16 v[108:111], v[240:241], v[234:235], 0
  v_mfma_f32_4x4x4_16b_bf16 v[64:67], a[70:71], v[230:231], v[64:67]
  v_mfma_f32_4x4x4_16b_bf16 v[68:71], a[72:73], v[230:231], v[68:71]
  v_mfma_f32_4x4x4_16b_bf16 v[72:75], a[74:75], v[230:231], v[72:75]
  v_mfma_f32_4x4x4_16b_bf16 v[76:79], a[76:77], v[230:231], v[76:79]
  v_mfma_f32_4x4x4_16b_bf16 v[80:83], a[78:79], v[230:231], v[80:83]
  v_mfma_f32_4x4x4_16b_bf16 v[84:87], v[240:241], v[230:231], v[84:87]
  v_mfma_f32_4x4x4_16b_bf16 v[88:91], a[100:101], v[236:237], v[88:91]
  v_mfma_f32_4x4x4_16b_bf16 v[92:95], a[102:103], v[236:237], v[92:95]
  v_mfma_f32_4x4x4_16b_bf16 v[96:99], a[104:105], v[236:237], v[96:99]
  v_mfma_f32_4x4x4_16b_bf16 v[100:103], a[106:107], v[236:237], v[100:103]
  s_waitcnt lgkmcnt(1)
  v_mfma_f32_4x4x4_16b_bf16 v[104:107], a[108:109], v[236:237], v[104:107]
  v_mfma_f32_4x4x4_16b_bf16 v[108:111], v[240:241], v[236:237], v[108:111]
  v_mfma_f32_4x4x4_16b_bf16 v[64:67], a[80:81], v[232:233], v[64:67]
  v_mfma_f32_4x4x4_16b_bf16 v[68:71], a[82:83], v[232:233], v[68:71]
  v_mfma_f32_4x4x4_16b_bf16 v[72:75], a[84:85], v[232:233], v[72:75]
  v_mfma_f32_4x4x4_16b_bf16 v[76:79], a[86:87], v[232:233], v[76:79]
  v_mfma_f32_4x4x4_16b_bf16 v[80:83], a[88:89], v[232:233], v[80:83]
  v_mfma_f32_4x4x4_16b_bf16 v[84:87], v[240:241], v[232:233], v[84:87]
  v_mfma_f32_4x4x4_16b_bf16 v[88:91], a[110:111], v[238:239], v[88:91]
  v_mfma_f32_4x4x4_16b_bf16 v[92:95], a[112:113], v[238:239], v[92:95]
  v_mfma_f32_4x4x4_16b_bf16 v[96:99], a[114:115], v[238:239], v[96:99]
  v_mfma_f32_4x4x4_16b_bf16 v[100:103], a[116:117], v[238:239], v[100:103]
  s_waitcnt lgkmcnt(0)
  v_mfma_f32_4x4x4_16b_bf16 v[104:107], a[118:119], v[238:239], v[104:107]
  v_mfma_f32_4x4x4_16b_bf16 v[108:111], v[240:241], v[238:239], v[108:111]
  s_waitcnt vmcnt(2)
  s_barrier
  s_nop 2
  s_branch L_m2done
L_m2b:
  v_pk_mul_f32 v[184:185], v[144:145], s[82:83]
  v_pk_add_f32 v[144:145], v[144:145], 1.0 op_sel_hi:[1,0]
  v_pk_mul_f32 v[186:187], v[146:147], s[82:83]
  v_pk_add_f32 v[146:147], v[146:147], 1.0 op_sel_hi:[1,0]
  v_pk_mul_f32 v[188:189], v[148:149], s[82:83]
  v_pk_add_f32 v[148:149], v[148:149], 1.0 op_sel_hi:[1,0]
  v_pk_mul_f32 v[190:191], v[150:151], s[82:83]
  v_pk_add_f32 v[150:151], v[150:151], 1.0 op_sel_hi:[1,0]
  v_pk_mul_f32 v[192:193], v[152:153], s[82:83]
  v_pk_add_f32 v[152:153], v[152:153], 1.0 op_sel_hi:[1,0]
  v_pk_mul_f32 v[194:195], v[154:155], s[82:83]
  v_pk_add_f32 v[154:155], v[154:155], 1.0 op_sel_hi:[1,0]
  v_pk_mul_f32 v[196:197], v[156:157], s[82:83]
  v_pk_add_f32 v[156:157], v[156:157], 1.0 op_sel_hi:[1,0]
  v_pk_mul_f32 v[198:199], v[158:159], s[82:83]
  v_pk_add_f32 v[158:159], v[158:159], 1.0 op_sel_hi:[1,0]
  v_pk_mul_f32 v[200:201], v[160:161], s[82:83]
  v_pk_add_f32 v[160:161], v[160:161], 1.0 op_sel_hi:[1,0]
  v_pk_mul_f32 v[202:203], v[162:163], s[82:83]
  v_pk_add_f32 v[162:163], v[162:163], 1.0 op_sel_hi:[1,0]
  v_pk_mul_f32 v[204:205], v[164:165], s[82:83]
  v_pk_add_f32 v[164:165], v[164:165], 1.0 op_sel_hi:[1,0]
  v_pk_mul_f32 v[206:207], v[166:167], s[82:83]
  v_pk_add_f32 v[166:167], v[166:167], 1.0 op_sel_hi:[1,0]
  v_pk_mul_f32 v[208:209], v[168:169], s[82:83]
  v_pk_add_f32 v[168:169], v[168:169], 1.0 op_sel_hi:[1,0]
  v_pk_mul_f32 v[210:211], v[170:171], s[82:83]
  v_pk_add_f32 v[170:171], v[170:171], 1.0 op_sel_hi:[1,0]
  v_pk_mul_f32 v[212:213], v[172:173], s[82:83]
  v_pk_add_f32 v[172:173], v[172:173], 1.0 op_sel_hi:[1,0]
  v_pk_mul_f32 v[214:215], v[174:175], s[82:83]
  v_pk_add_f32 v[174:175], v[174:175], 1.0 op_sel_hi:[1,0]
  v_pk_mul_f32 v[216:217], v[176:177], s[82:83]
  v_pk_add_f32 v[176:177], v[176:177], 1.0 op_sel_hi:[1,0]
  v_pk_mul_f32 v[218:219], v[178:179], s[82:83]
  v_pk_add_f32 v[178:179], v[178:179], 1.0 op_sel_hi:[1,0]
  v_pk_mul_f32 v[220:221], v[180:181], s[82:83]
  v_pk_add_f32 v[180:181], v[180:181], 1.0 op_sel_hi:[1,0]
  v_pk_mul_f32 v[222:223], v[182:183], s[82:83]
  v_pk_add_f32 v[182:183], v[182:183], 1.0 op_sel_hi:[1,0]
  v_exp_f32_e64 v184, v184 clamp
  v_exp_f32_e64 v185, v185 clamp
  v_exp_f32_e64 v186, v186 clamp
  v_exp_f32_e64 v187, v187 clamp
  v_exp_f32_e64 v188, v188 clamp
  v_exp_f32_e64 v189, v189 clamp
  v_exp_f32_e64 v190, v190 clamp
  v_exp_f32_e64 v191, v191 clamp
  v_exp_f32_e64 v192, v192 clamp
  v_exp_f32_e64 v193, v193 clamp
  v_exp_f32_e64 v194, v194 clamp
  v_exp_f32_e64 v195, v195 clamp
  v_exp_f32_e64 v196, v196 clamp
  v_exp_f32_e64 v197, v197 clamp
  v_exp_f32_e64 v198, v198 clamp
  v_exp_f32_e64 v199, v199 clamp
  v_exp_f32_e64 v200, v200 clamp
  v_exp_f32_e64 v201, v201 clamp
  v_exp_f32_e64 v202, v202 clamp
  v_exp_f32_e64 v203, v203 clamp
  v_exp_f32_e64 v204, v204 clamp
  v_exp_f32_e64 v205, v205 clamp
  v_exp_f32_e64 v206, v206 clamp
  v_exp_f32_e64 v207, v207 clamp
  v_exp_f32_e64 v208, v208 clamp
  v_exp_f32_e64 v209, v209 clamp
  v_exp_f32_e64 v210, v210 clamp
  v_exp_f32_e64 v211, v211 clamp
  v_exp_f32_e64 v212, v212 clamp
  v_exp_f32_e64 v213, v213 clamp
  v_exp_f32_e64 v214, v214 clamp
  v_exp_f32_e64 v215, v215 clamp
  v_exp_f32_e64 v216, v216 clamp
  v_exp_f32_e64 v217, v217 clamp
  v_exp_f32_e64 v218, v218 clamp
  v_exp_f32_e64 v219, v219 clamp
  v_exp_f32_e64 v220, v220 clamp
  v_exp_f32_e64 v221, v221 clamp
  v_exp_f32_e64 v222, v222 clamp
  v_exp_f32_e64 v223, v223 clamp
  v_max_f32 v144, v144, v184
  v_max_f32 v145, v145, v185
  v_max_f32 v146, v146, v186
  v_max_f32 v147, v147, v187
  v_max_f32 v148, v148, v188
  v_max_f32 v149, v149, v189
  v_max_f32 v150, v150, v190
  v_max_f32 v151, v151, v191
  v_max_f32 v152, v152, v192
  v_max_f32 v153, v153, v193
  v_max_f32 v154, v154, v194
  v_max_f32 v155, v155, v195
  v_max_f32 v156, v156, v196
  v_max_f32 v157, v157, v197
  v_max_f32 v158, v158, v198
  v_max_f32 v159, v159, v199
  v_max_f32 v160, v160, v200
  v_max_f32 v161, v161, v201
  v_max_f32 v162, v162, v202
  v_max_f32 v163, v163, v203
  v_max_f32 v164, v164, v204
  v_max_f32 v165, v165, v205
  v_max_f32 v166, v166, v206
  v_max_f32 v167, v167, v207
  v_max_f32 v168, v168, v208
  v_max_f32 v169, v169, v209
  v_max_f32 v170, v170, v210
  v_max_f32 v171, v171, v211
  v_max_f32 v172, v172, v212
  v_max_f32 v173, v173, v213
  v_max_f32 v174, v174, v214
  v_max_f32 v175, v175, v215
  v_max_f32 v176, v176, v216
  v_max_f32 v177, v177, v217
  v_max_f32 v178, v178, v218
  v_max_f32 v179, v179, v219
  v_max_f32 v180, v180, v220
  v_max_f32 v181, v181, v221
  v_max_f32 v182, v182, v222
  v_max_f32 v183, v183, v223
  v_pk_add_f32 v[144:145], v[144:145], s[86:87]
  v_pk_add_f32 v[146:147], v[146:147], s[86:87]
  v_pk_add_f32 v[148:149], v[148:149], s[86:87]
  v_pk_add_f32 v[150:151], v[150:151], s[86:87]
  v_pk_add_f32 v[152:153], v[152:153], s[86:87]
  v_pk_add_f32 v[154:155], v[154:155], s[86:87]
  v_pk_add_f32 v[156:157], v[156:157], s[86:87]
  v_pk_add_f32 v[158:159], v[158:159], s[86:87]
  v_pk_add_f32 v[160:161], v[160:161], s[86:87]
  v_pk_add_f32 v[162:163], v[162:163], s[86:87]
  v_pk_add_f32 v[164:165], v[164:165], s[86:87]
  v_pk_add_f32 v[166:167], v[166:167], s[86:87]
  v_pk_add_f32 v[168:169], v[168:169], s[86:87]
  v_pk_add_f32 v[170:171], v[170:171], s[86:87]
  v_pk_add_f32 v[172:173], v[172:173], s[86:87]
  v_pk_add_f32 v[174:175], v[174:175], s[86:87]
  v_pk_add_f32 v[176:177], v[176:177], s[86:87]
  v_pk_add_f32 v[178:179], v[178:179], s[86:87]
  v_pk_add_f32 v[180:181], v[180:181], s[86:87]
  v_pk_add_f32 v[182:183], v[182:183], s[86:87]
  s_mov_b32 exec_lo, 0xffffffff
  s_mov_b32 exec_hi, 0xff
  buffer_load_dword v32, v252, s[8:11], s44 offen sc1
  s_mov_b64 exec, 1
  buffer_load_dword v32, v51, s[24:27], s49 offen sc1
  s_mov_b64 exec, -1
  v_cvt_pk_bf16_f32 v144, v144, v145
  v_cvt_pk_bf16_f32 v145, v146, v147
  v_cvt_pk_bf16_f32 v148, v148, v149
  v_cvt_pk_bf16_f32 v149, v150, v151
  v_cvt_pk_bf16_f32 v152, v152, v153
  v_cvt_pk_bf16_f32 v153, v154, v155
  v_cvt_pk_bf16_f32 v156, v156, v157
  v_cvt_pk_bf16_f32 v157, v158, v159
  v_cvt_pk_bf16_f32 v160, v160, v161
  v_cvt_pk_bf16_f32 v161, v162, v163
  v_cvt_pk_bf16_f32 v164, v164, v165
  v_cvt_pk_bf16_f32 v165, v166, v167
  v_cvt_pk_bf16_f32 v168, v168, v169
  v_cvt_pk_bf16_f32 v169, v170, v171
  v_cvt_pk_bf16_f32 v172, v172, v173
  v_cvt_pk_bf16_f32 v173, v174, v175
  v_cvt_pk_bf16_f32 v176, v176, v177
  v_cvt_pk_bf16_f32 v177, v178, v179
  v_cvt_pk_bf16_f32 v180, v180, v181
  v_cvt_pk_bf16_f32 v181, v182, v183
  s_lshl_b32 s3, s31, 5
  s_add_u32 s3, s3, 143936
  v_lshl_add_u32 v6, v50, 3, s3
  v_mul_u32_u24 v7, 768, v4
  v_lshl_add_u32 v23, v49, 7, v6
  v_add_u32 v23, v23, v7
  s_mov_b32 s4, 0x00ffff00
  s_mov_b32 s5, 0xff00ff00
  v_mov_b32 v24, 3072
  v_cndmask_b32 v7, v7, v24, s[4:5]
  v_and_b32 v24, 1, v49
  v_add_u32 v24, 4, v24
  s_mov_b32 s5, 0
  v_cndmask_b32 v24, v24, v49, s[4:5]
  v_lshl_add_u32 v24, v24, 7, v6
  v_add_u32 v24, v24, v7
  v_lshl_add_u32 v7, v4, 2, v50
  v_lshlrev_b32 v7, 3, v7
  v_add_u32 v7, 143936, v7
  s_waitcnt vmcnt(2)
  v_cvt_pk_bf16_f32 v72, v64, v65
  v_cvt_pk_bf16_f32 v73, v66, v67
  v_cvt_pk_bf16_f32 v74, v68, v69
  v_cvt_pk_bf16_f32 v75, v70, v71
  ds_write_b64 v23, v[72:73]
  ds_write_b64 v24, v[74:75]
  s_waitcnt lgkmcnt(0)
  s_barrier
  ds_read_b64 a[0:1], v7 offset:0
  ds_read_b64 a[2:3], v7 offset:128
  ds_read_b64 a[4:5], v7 offset:256
  ds_read_b64 a[6:7], v7 offset:384
  ds_read_b64 a[8:9], v7 offset:512
  ds_read_b64 a[10:11], v7 offset:640
  ds_read_b64 a[12:13], v7 offset:768
  ds_read_b64 a[14:15], v7 offset:896
  s_waitcnt lgkmcnt(7)
  v_mfma_f32_4x4x4_16b_bf16 v[64:67], a[0:1], v[144:145], 0
  ds_read_b64 a[16:17], v7 offset:1024
  v_mfma_f32_4x4x4_16b_bf16 v[88:91], a[0:1], v[148:149], 0
  s_waitcnt lgkmcnt(7)
  v_mfma_f32_4x4x4_16b_bf16 v[68:71], a[2:3], v[144:145], 0
  ds_read_b64 a[18:19], v7 offset:1152
  v_mfma_f32_4x4x4_16b_bf16 v[92:95], a[2:3], v[148:149], 0
  s_waitcnt lgkmcnt(7)
  v_mfma_f32_4x4x4_16b_bf16 v[72:75], a[4:5], v[144:145], 0
  ds_read_b64 a[20:21], v7 offset:1280
  v_mfma_f32_4x4x4_16b_bf16 v[96:99], a[4:5], v[148:149], 0
  s_waitcnt lgkmcnt(7)
  v_mfma_f32_4x4x4_16b_bf16 v[76:79], a[6:7], v[144:145], 0
  ds_read_b64 a[22:23], v7 offset:1408
  v_mfma_f32_4x4x4_16b_bf16 v[100:103], a[6:7], v[148:149], 0
  s_waitcnt lgkmcnt(7)
  v_mfma_f32_4x4x4_16b_bf16 v[80:83], a[8:9], v[144:145], 0
  ds_read_b64 a[24:25], v7 offset:1536
  v_mfma_f32_4x4x4_16b_bf16 v[104:107], a[8:9], v[148:149], 0
  s_waitcnt lgkmcnt(7)
  v_mfma_f32_4x4x4_16b_bf16 v[84:87], a[10:11], v[144:145], 0
  ds_read_b64 a[26:27], v7 offset:1664
  v_mfma_f32_4x4x4_16b_bf16 v[108:111], a[10:11], v[148:149], 0
  s_waitcnt lgkmcnt(7)
  v_mfma_f32_4x4x4_16b_bf16 v[64:67], a[12:13], v[152:153], v[64:67]
  ds_read_b64 a[28:29], v7 offset:1792
  v_mfma_f32_4x4x4_16b_bf16 v[88:91], a[12:13], v[156:157], v[88:91]
  s_waitcnt lgkmcnt(7)
  v_mfma_f32_4x4x4_16b_bf16 v[68:71], a[14:15], v[152:153], v[68:71]
  ds_read_b64 a[30:31], v7 offset:1920
  v_mfma_f32_4x4x4_16b_bf16 v[92:95], a[14:15], v[156:157], v[92:95]
  s_waitcnt lgkmcnt(7)
  v_mfma_f32_4x4x4_16b_bf16 v[72:75], a[16:17], v[152:153], v[72:75]
  ds_read_b64 a[32:33], v7 offset:2048
  v_mfma_f32_4x4x4_16b_bf16 v[96:99], a[16:17], v[156:157], v[96:99]
  s_waitcnt lgkmcnt(7)
  v_mfma_f32_4x4x4_16b_bf16 v[76:79], a[18:19], v[152:153], v[76:79]
  ds_read_b64 a[34:35], v7 offset:2176
  v_mfma_f32_4x4x4_16b_bf16 v[100:103], a[18:19], v[156:157], v[100:103]
  s_waitcnt lgkmcnt(7)
  v_mfma_f32_4x4x4_16b_bf16 v[80:83], a[20:21], v[152:153], v[80:83]
  ds_read_b64 a[36:37], v7 offset:2304
  v_mfma_f32_4x4x4_16b_bf16 v[104:107], a[20:21], v[156:157], v[104:107]
  s_waitcnt lgkmcnt(7)
  v_mfma_f32_4x4x4_16b_bf16 v[84:87], a[22:23], v[152:153], v[84:87]
  ds_read_b64 a[38:39], v7 offset:2432
  v_mfma_f32_4x4x4_16b_bf16 v[108:111], a[22:23], v[156:157], v[108:111]
  s_waitcnt lgkmcnt(7)
  v_mfma_f32_4x4x4_16b_bf16 v[64:67], a[24:25], v[160:161], v[64:67]
  ds_read_b64 a[40:41], v7 offset:2560
  v_mfma_f32_4x4x4_16b_bf16 v[88:91], a[24:25], v[164:165], v[88:91]
  s_waitcnt lgkmcnt(7)
  v_mfma_f32_4x4x4_16b_bf16 v[68:71], a[26:27], v[160:161], v[68:71]
  ds_read_b64 a[42:43], v7 offset:2688
  v_mfma_f32_4x4x4_16b_bf16 v[92:95], a[26:27], v[164:165], v[92:95]
  s_waitcnt lgkmcnt(7)
  v_mfma_f32_4x4x4_16b_bf16 v[72:75], a[28:29], v[160:161], v[72:75]
  ds_read_b64 a[44:45], v7 offset:2816
  v_mfma_f32_4x4x4_16b_bf16 v[96:99], a[28:29], v[164:165], v[96:99]
  s_waitcnt lgkmcnt(7)
  v_mfma_f32_4x4x4_16b_bf16 v[76:79], a[30:31], v[160:161], v[76:79]
  ds_read_b64 a[46:47], v7 offset:2944
  v_mfma_f32_4x4x4_16b_bf16 v[100:103], a[30:31], v[164:165], v[100:103]
  s_waitcnt lgkmcnt(7)
  v_mfma_f32_4x4x4_16b_bf16 v[80:83], a[32:33], v[160:161], v[80:83]
  ds_read_b64 a[48:49], v7 offset:3072
  v_mfma_f32_4x4x4_16b_bf16 v[104:107], a[32:33], v[164:165], v[104:107]
  s_waitcnt lgkmcnt(7)
  v_mfma_f32_4x4x4_16b_bf16 v[84:87], a[34:35], v[160:161], v[84:87]
  ds_read_b64 a[50:51], v7 offset:3200
  v_mfma_f32_4x4x4_16b_bf16 v[108:111], a[34:35], v[164:165], v[108:111]
  s_waitcnt lgkmcnt(7)
  v_mfma_f32_4x4x4_16b_bf16 v[64:67], a[36:37], v[168:169], v[64:67]
  ds_read_b64 a[52:53], v7 offset:3328
  v_mfma_f32_4x4x4_16b_bf16 v[88:91], a[36:37], v[172:173], v[88:91]
  s_waitcnt lgkmcnt(7)
  v_mfma_f32_4x4x4_16b_bf16 v[68:71], a[38:39], v[168:169], v[68:71]
  ds_read_b64 a[54:55], v7 offset:3456
  v_mfma_f32_4x4x4_16b_bf16 v[92:95], a[38:39], v[172:173], v[92:95]
  s_waitcnt lgkmcnt(7)
  v_mfma_f32_4x4x4_16b_bf16 v[72:75], a[40:41], v[168:169], v[72:75]
  ds_read_b64 a[56:57], v7 offset:3584
  v_mfma_f32_4x4x4_16b_bf16 v[96:99], a[40:41], v[172:173], v[96:99]
  s_waitcnt lgkmcnt(7)
  v_mfma_f32_4x4x4_16b_bf16 v[76:79], a[42:43], v[168:169], v[76:79]
  ds_read_b64 a[58:59], v7 offset:3712
  v_mfma_f32_4x4x4_16b_bf16 v[100:103], a[42:43], v[172:173], v[100:103]
  s_waitcnt lgkmcnt(7)
  v_mfma_f32_4x4x4_16b_bf16 v[80:83], a[44:45], v[168:169], v[80:83]
  v_mfma_f32_4x4x4_16b_bf16 v[104:107], a[44:45], v[172:173], v[104:107]
  s_waitcnt lgkmcnt(6)
  v_mfma_f32_4x4x4_16b_bf16 v[84:87], a[46:47], v[168:169], v[84:87]
  v_mfma_f32_4x4x4_16b_bf16 v[108:111], a[46:47], v[172:173], v[108:111]
  s_waitcnt lgkmcnt(5)
  v_mfma_f32_4x4x4_16b_bf16 v[64:67], a[48:49], v[176:177], v[64:67]
  v_mfma_f32_4x4x4_16b_bf16 v[88:91], a[48:49], v[180:181], v[88:91]
  s_waitcnt lgkmcnt(4)
  v_mfma_f32_4x4x4_16b_bf16 v[68:71], a[50:51], v[176:177], v[68:71]
  v_mfma_f32_4x4x4_16b_bf16 v[92:95], a[50:51], v[180:181], v[92:95]
  s_waitcnt lgkmcnt(3)
  v_mfma_f32_4x4x4_16b_bf16 v[72:75], a[52:53], v[176:177], v[72:75]
  v_mfma_f32_4x4x4_16b_bf16 v[96:99], a[52:53], v[180:181], v[96:99]
  s_waitcnt lgkmcnt(2)
  v_mfma_f32_4x4x4_16b_bf16 v[76:79], a[54:55], v[176:177], v[76:79]
  v_mfma_f32_4x4x4_16b_bf16 v[100:103], a[54:55], v[180:181], v[100:103]
  s_waitcnt lgkmcnt(1)
  v_mfma_f32_4x4x4_16b_bf16 v[80:83], a[56:57], v[176:177], v[80:83]
  v_mfma_f32_4x4x4_16b_bf16 v[104:107], a[56:57], v[180:181], v[104:107]
  s_waitcnt lgkmcnt(0)
  v_mfma_f32_4x4x4_16b_bf16 v[84:87], a[58:59], v[176:177], v[84:87]
  v_mfma_f32_4x4x4_16b_bf16 v[108:111], a[58:59], v[180:181], v[108:111]
  s_nop 3
  v_add_f32 v84, s53, v84
  v_add_f32 v108, s53, v108
  s_nop 1
L_m2done:
  v_rcp_f32 v84, v84
  v_rcp_f32 v108, v108
  s_add_u32 s3, s30, 0
  s_and_b32 s3, s3, 7
  s_mul_i32 s4, s3, 12800
  s_mul_i32 s58, s3, 10240
  v_add_u32 v196, s4, v28
  s_add_u32 s58, s58, s44
  v_add_u32 v253, 5120, v46
  s_lshr_b32 s3, s30, 1
  s_mul_i32 s3, s3, 20480
  s_add_u32 s3, s3, s44
  s_add_u32 s4, s3, 10240
  s_lshl_b32 s5, s30, 2
  s_add_u32 s5, s5, s49
  v_pk_mul_f32 v[64:65], v[64:65], v[84:85] op_sel_hi:[1,0]
  v_pk_mul_f32 v[66:67], v[66:67], v[84:85] op_sel_hi:[1,0]
  v_cvt_pk_bf16_f32 v112, v64, v65
  v_cvt_pk_bf16_f32 v113, v66, v67
  v_pk_mul_f32 v[68:69], v[68:69], v[84:85] op_sel_hi:[1,0]
  v_pk_mul_f32 v[70:71], v[70:71], v[84:85] op_sel_hi:[1,0]
  v_cvt_pk_bf16_f32 v114, v68, v69
  v_cvt_pk_bf16_f32 v115, v70, v71
  v_pk_mul_f32 v[72:73], v[72:73], v[84:85] op_sel_hi:[1,0]
  v_pk_mul_f32 v[74:75], v[74:75], v[84:85] op_sel_hi:[1,0]
  v_cvt_pk_bf16_f32 v116, v72, v73
  v_cvt_pk_bf16_f32 v117, v74, v75
  v_pk_mul_f32 v[76:77], v[76:77], v[84:85] op_sel_hi:[1,0]
  v_pk_mul_f32 v[78:79], v[78:79], v[84:85] op_sel_hi:[1,0]
  v_cvt_pk_bf16_f32 v118, v76, v77
  v_cvt_pk_bf16_f32 v119, v78, v79
  v_pk_mul_f32 v[80:81], v[80:81], v[84:85] op_sel_hi:[1,0]
  v_pk_mul_f32 v[82:83], v[82:83], v[84:85] op_sel_hi:[1,0]
  v_cvt_pk_bf16_f32 v120, v80, v81
  v_cvt_pk_bf16_f32 v121, v82, v83
  v_pk_mul_f32 v[88:89], v[88:89], v[108:109] op_sel_hi:[1,0]
  v_pk_mul_f32 v[90:91], v[90:91], v[108:109] op_sel_hi:[1,0]
  v_cvt_pk_bf16_f32 v122, v88, v89
  v_cvt_pk_bf16_f32 v123, v90, v91
  v_pk_mul_f32 v[92:93], v[92:93], v[108:109] op_sel_hi:[1,0]
  v_pk_mul_f32 v[94:95], v[94:95], v[108:109] op_sel_hi:[1,0]
  v_cvt_pk_bf16_f32 v124, v92, v93
  v_cvt_pk_bf16_f32 v125, v94, v95
  v_pk_mul_f32 v[96:97], v[96:97], v[108:109] op_sel_hi:[1,0]
  v_pk_mul_f32 v[98:99], v[98:99], v[108:109] op_sel_hi:[1,0]
  v_cvt_pk_bf16_f32 v126, v96, v97
  v_cvt_pk_bf16_f32 v127, v98, v99
  v_pk_mul_f32 v[100:101], v[100:101], v[108:109] op_sel_hi:[1,0]
  v_pk_mul_f32 v[102:103], v[102:103], v[108:109] op_sel_hi:[1,0]
  v_cvt_pk_bf16_f32 v128, v100, v101
  v_cvt_pk_bf16_f32 v129, v102, v103
  v_pk_mul_f32 v[104:105], v[104:105], v[108:109] op_sel_hi:[1,0]
  v_pk_mul_f32 v[106:107], v[106:107], v[108:109] op_sel_hi:[1,0]
  v_cvt_pk_bf16_f32 v130, v104, v105
  v_cvt_pk_bf16_f32 v131, v106, v107
  v_mov_b32 v6, s39
  v_mov_b32 v7, 0
  s_cmp_eq_u32 s80, 0
  s_nop 0
  s_cbranch_scc1 L_slow0
  buffer_store_dwordx4 v[112:115], v46, s[8:11], s58 offen offset:0
  buffer_store_dwordx4 v[116:119], v253, s[8:11], s58 offen offset:0
  buffer_store_dwordx2 v[120:121], v47, s[8:11], s3 offen
  buffer_store_dwordx4 v[122:125], v46, s[8:11], s58 offen offset:2560
  buffer_store_dwordx4 v[126:129], v253, s[8:11], s58 offen offset:2560
  buffer_store_dwordx2 v[130:131], v47, s[8:11], s4 offen
  s_nop 0
  s_branch L_pub0
L_slow0:
  buffer_store_dwordx4 v[112:115], v46, s[8:11], s58 offen offset:0 sc1
  buffer_store_dwordx4 v[116:119], v253, s[8:11], s58 offen offset:0 sc1
  buffer_store_dwordx2 v[120:121], v47, s[8:11], s3 offen sc1
  buffer_store_dwordx4 v[122:125], v46, s[8:11], s58 offen offset:2560 sc1
  buffer_store_dwordx4 v[126:129], v253, s[8:11], s58 offen offset:2560 sc1
  buffer_store_dwordx2 v[130:131], v47, s[8:11], s4 offen sc1
  s_nop 0
L_pub0:
  ds_read_b64_tr_b16 a[160:161], v196 offset:0
  ds_read_b64_tr_b16 a[162:163], v196 offset:640
  ds_read_b64_tr_b16 a[164:165], v196 offset:8
  ds_read_b64_tr_b16 a[166:167], v196 offset:648
  ds_read_b64_tr_b16 a[168:169], v196 offset:16
  ds_read_b64_tr_b16 a[170:171], v196 offset:656
  ds_read_b64_tr_b16 a[172:173], v196 offset:24
  ds_read_b64_tr_b16 a[174:175], v196 offset:664
  ds_read_b64_tr_b16 a[176:177], v196 offset:32
  ds_read_b64_tr_b16 a[178:179], v196 offset:672
  ds_read_b64_tr_b16 a[180:181], v196 offset:1280
  ds_read_b64_tr_b16 a[182:183], v196 offset:1920
  s_add_u32 s3, s30, 1
  s_and_b32 s3, s3, 7
  s_mul_i32 s4, s3, 12800
  s_mul_i32 s59, s3, 10240
  v_add_u32 v197, s4, v28
  s_add_u32 s59, s59, s44
  s_waitcnt lgkmcnt(10)
  v_mfma_f32_16x16x32_bf16 v[144:147], a[160:163], v[112:115], 0
  ds_read_b64_tr_b16 a[184:185], v196 offset:1288
  v_mfma_f32_16x16x32_bf16 v[148:151], a[160:163], v[122:125], 0
  ds_read_b64_tr_b16 a[186:187], v196 offset:1928
  s_waitcnt lgkmcnt(10)
  v_mfma_f32_16x16x32_bf16 v[152:155], a[164:167], v[112:115], 0
  ds_read_b64_tr_b16 a[188:189], v196 offset:1296
  v_mfma_f32_16x16x32_bf16 v[156:159], a[164:167], v[122:125], 0
  ds_read_b64_tr_b16 a[190:191], v196 offset:1936
  s_waitcnt lgkmcnt(10)
  v_mfma_f32_16x16x32_bf16 v[160:163], a[168:171], v[112:115], 0
  ds_read_b64_tr_b16 a[160:161], v196 offset:1304
  v_mfma_f32_16x16x32_bf16 v[164:167], a[168:171], v[122:125], 0
  ds_read_b64_tr_b16 a[162:163], v196 offset:1944
  s_waitcnt lgkmcnt(10)
  v_mfma_f32_16x16x32_bf16 v[168:171], a[172:175], v[112:115], 0
  ds_read_b64_tr_b16 a[164:165], v196 offset:1312
  v_mfma_f32_16x16x32_bf16 v[172:175], a[172:175], v[122:125], 0
  ds_read_b64_tr_b16 a[166:167], v196 offset:1952
  s_waitcnt lgkmcnt(10)
  v_mfma_f32_16x16x32_bf16 v[176:179], a[176:179], v[112:115], 0
  ds_read_b64_tr_b16 a[168:169], v197 offset:0
  v_mfma_f32_16x16x32_bf16 v[180:183], a[176:179], v[122:125], 0
  ds_read_b64_tr_b16 a[170:171], v197 offset:640
  s_waitcnt lgkmcnt(10)
  v_mfma_f32_16x16x32_bf16 v[144:147], a[180:183], v[116:119], v[144:147]
  ds_read_b64_tr_b16 a[172:173], v197 offset:8
  v_mfma_f32_16x16x32_bf16 v[148:151], a[180:183], v[126:129], v[148:151]
  ds_read_b64_tr_b16 a[174:175], v197 offset:648
  s_waitcnt lgkmcnt(10)
  v_mfma_f32_16x16x32_bf16 v[152:155], a[184:187], v[116:119], v[152:155]
  ds_read_b64_tr_b16 a[176:177], v197 offset:16
  v_mfma_f32_16x16x32_bf16 v[156:159], a[184:187], v[126:129], v[156:159]
  ds_read_b64_tr_b16 a[178:179], v197 offset:656
  s_waitcnt lgkmcnt(10)
  v_mfma_f32_16x16x32_bf16 v[160:163], a[188:191], v[116:119], v[160:163]
  ds_read_b64_tr_b16 a[180:181], v197 offset:24
  v_mfma_f32_16x16x32_bf16 v[164:167], a[188:191], v[126:129], v[164:167]
  ds_read_b64_tr_b16 a[182:183], v197 offset:664
  s_waitcnt lgkmcnt(10)
  v_mfma_f32_16x16x32_bf16 v[168:171], a[160:163], v[116:119], v[168:171]
  ds_read_b64_tr_b16 a[184:185], v197 offset:32
  v_mfma_f32_16x16x32_bf16 v[172:175], a[160:163], v[126:129], v[172:175]
  ds_read_b64_tr_b16 a[186:187], v197 offset:672
  s_waitcnt lgkmcnt(10)
  v_mfma_f32_16x16x32_bf16 v[176:179], a[164:167], v[116:119], v[176:179]
  ds_read_b64_tr_b16 a[188:189], v197 offset:1280
  v_mfma_f32_16x16x32_bf16 v[180:183], a[164:167], v[126:129], v[180:183]
  ds_read_b64_tr_b16 a[190:191], v197 offset:1920
  s_waitcnt vmcnt(0)
  s_cmp_eq_u32 s80, 0
  s_nop 4
  s_cbranch_scc1 L_slow1
  s_mov_b64 exec, 1
  buffer_store_dword v6, v7, s[24:27], s5 offen
  s_mov_b64 exec, -1
  s_branch L_pub1
L_slow1:
  s_mov_b64 exec, 1
  buffer_store_dword v6, v7, s[24:27], s5 offen sc1
  s_mov_b64 exec, -1
L_pub1:
  s_barrier
  s_add_u32 s3, s30, 2
  s_and_b32 s3, s3, 7
  s_mul_i32 s4, s3, 12800
  s_mul_i32 s60, s3, 10240
  v_add_u32 v198, s4, v28
  s_add_u32 s60, s60, s44
  s_add_u32 s3, s30, 3
  s_and_b32 s3, s3, 7
  s_mul_i32 s4, s3, 12800
  s_mul_i32 s61, s3, 10240
  v_add_u32 v199, s4, v28
  s_add_u32 s61, s61, s44
  s_add_u32 s3, s30, 4
  s_and_b32 s3, s3, 7
  s_mul_i32 s4, s3, 12800
  s_mul_i32 s62, s3, 10240
  v_add_u32 v200, s4, v28
  s_add_u32 s62, s62, s44
  s_add_u32 s3, s30, 5
  s_and_b32 s3, s3, 7
  s_mul_i32 s4, s3, 12800
  s_mul_i32 s63, s3, 10240
  v_add_u32 v201, s4, v28
  s_add_u32 s63, s63, s44
  s_add_u32 s3, s30, 6
  s_and_b32 s3, s3, 7
  s_mul_i32 s4, s3, 12800
  s_mul_i32 s64, s3, 10240
  v_add_u32 v202, s4, v28
  s_add_u32 s64, s64, s44
  s_add_u32 s3, s30, 7
  s_and_b32 s3, s3, 7
  s_mul_i32 s4, s3, 12800
  s_mul_i32 s65, s3, 10240
  v_add_u32 v203, s4, v28
  s_add_u32 s65, s65, s44
  v_mul_u32_u24 v251, 2304, v4
  v_add_u32 v251, v251, v46
  v_add_u32 v251, 1024, v251
  v_mul_u32_u24 v23, 6554, v1
  v_add_u32 v7, s79, v46
  s_movk_i32 s3, 4960
  s_mov_b32 s4, 79360
  v_lshrrev_b32 v195, 16, v23
  v_lshl_add_u32 v184, v195, 4, v7
  v_mad_u32_u24 v189, v195, s3, v46
  v_add_u32 v195, 419456, v23
  v_lshrrev_b32 v195, 16, v195
  v_lshl_add_u32 v185, v195, 4, v7
  v_mad_u32_u24 v190, v195, s3, v46
  v_add_u32 v195, 838912, v23
  v_lshrrev_b32 v195, 16, v195
  v_lshl_add_u32 v186, v195, 4, v7
  v_mad_u32_u24 v191, v195, s3, v46
  v_lshrrev_b32 v195, 4, v195
  v_mul_u32_u24 v195, s4, v195
  v_sub_u32 v191, v191, v195
  v_add_u32 v195, 1258368, v23
  v_lshrrev_b32 v195, 16, v195
  v_lshl_add_u32 v187, v195, 4, v7
  v_mad_u32_u24 v192, v195, s3, v46
  v_subrev_u32 v192, 79360, v192
  v_add_u32 v195, 1677824, v23
  v_lshrrev_b32 v195, 16, v195
  v_lshl_add_u32 v188, v195, 4, v7
  v_mad_u32_u24 v193, v195, s3, v46
  v_subrev_u32 v193, 75264, v193
  v_mul_u32_u24 v194, 176, v3
  v_mul_u32_u24 v195, 40, v4
  v_add3_u32 v194, v194, v195, s79
  v_min_u32 v7, 28, v51
  s_mov_b32 s46, 16384
  s_nop 0
L_spin4:
  buffer_load_dword v36, v7, s[24:27], s49 offen sc1
  s_waitcnt vmcnt(0)
  v_cmp_eq_u32 vcc, s39, v36
  s_nop 0
  s_cmp_eq_u64 vcc, -1
  s_nop 2
  s_cbranch_scc1 L_spun4
  s_sleep 1
  s_sub_u32 s46, s46, 1
  s_cmp_lg_u32 s46, 0
  s_cbranch_scc1 L_spin4
L_spun4:
  s_waitcnt vmcnt(0)
  buffer_load_dwordx4 a[0:3], v46, s[8:11], s59 offen offset:0 sc1
  buffer_load_dwordx4 a[4:7], v46, s[8:11], s59 offen offset:2560 sc1
  buffer_load_dwordx4 a[8:11], v253, s[8:11], s59 offen offset:0 sc1
  buffer_load_dwordx4 a[12:15], v253, s[8:11], s59 offen offset:2560 sc1
  buffer_load_dwordx4 a[16:19], v46, s[8:11], s60 offen offset:0 sc1
  buffer_load_dwordx4 a[20:23], v46, s[8:11], s60 offen offset:2560 sc1
  buffer_load_dwordx4 a[24:27], v253, s[8:11], s60 offen offset:0 sc1
  buffer_load_dwordx4 a[28:31], v253, s[8:11], s60 offen offset:2560 sc1
  s_waitcnt vmcnt(7) lgkmcnt(10)
  v_mfma_f32_16x16x32_bf16 v[144:147], a[168:171], a[0:3], v[144:147]
  ds_read_b64_tr_b16 a[160:161], v197 offset:1288
  s_waitcnt vmcnt(6)
  v_mfma_f32_16x16x32_bf16 v[148:151], a[168:171], a[4:7], v[148:151]
  ds_read_b64_tr_b16 a[162:163], v197 offset:1928
  buffer_load_dwordx4 a[32:35], v46, s[8:11], s61 offen offset:0 sc1
  s_waitcnt lgkmcnt(10)
  v_mfma_f32_16x16x32_bf16 v[152:155], a[172:175], a[0:3], v[152:155]
  ds_read_b64_tr_b16 a[164:165], v197 offset:1296
  v_mfma_f32_16x16x32_bf16 v[156:159], a[172:175], a[4:7], v[156:159]
  ds_read_b64_tr_b16 a[166:167], v197 offset:1936
  s_waitcnt lgkmcnt(10)
  v_mfma_f32_16x16x32_bf16 v[160:163], a[176:179], a[0:3], v[160:163]
  ds_read_b64_tr_b16 a[168:169], v197 offset:1304
  v_mfma_f32_16x16x32_bf16 v[164:167], a[176:179], a[4:7], v[164:167]
  ds_read_b64_tr_b16 a[170:171], v197 offset:1944
  buffer_load_dwordx4 a[36:39], v46, s[8:11], s61 offen offset:2560 sc1
  s_waitcnt lgkmcnt(10)
  v_mfma_f32_16x16x32_bf16 v[168:171], a[180:183], a[0:3], v[168:171]
  ds_read_b64_tr_b16 a[172:173], v197 offset:1312
  v_mfma_f32_16x16x32_bf16 v[172:175], a[180:183], a[4:7], v[172:175]
  ds_read_b64_tr_b16 a[174:175], v197 offset:1952
  s_waitcnt lgkmcnt(10)
  v_mfma_f32_16x16x32_bf16 v[176:179], a[184:187], a[0:3], v[176:179]
  ds_read_b64_tr_b16 a[176:177], v198 offset:0
  v_mfma_f32_16x16x32_bf16 v[180:183], a[184:187], a[4:7], v[180:183]
  ds_read_b64_tr_b16 a[178:179], v198 offset:640
  buffer_load_dwordx4 a[40:43], v253, s[8:11], s61 offen offset:0 sc1
  s_waitcnt vmcnt(8) lgkmcnt(10)
  v_mfma_f32_16x16x32_bf16 v[144:147], a[188:191], a[8:11], v[144:147]
  ds_read_b64_tr_b16 a[180:181], v198 offset:8
  s_waitcnt vmcnt(7)
  v_mfma_f32_16x16x32_bf16 v[148:151], a[188:191], a[12:15], v[148:151]
  ds_read_b64_tr_b16 a[182:183], v198 offset:648
  s_waitcnt lgkmcnt(10)
  v_mfma_f32_16x16x32_bf16 v[152:155], a[160:163], a[8:11], v[152:155]
  ds_read_b64_tr_b16 a[184:185], v198 offset:16
  v_mfma_f32_16x16x32_bf16 v[156:159], a[160:163], a[12:15], v[156:159]
  ds_read_b64_tr_b16 a[186:187], v198 offset:656
  buffer_load_dwordx4 a[44:47], v253, s[8:11], s61 offen offset:2560 sc1
  s_waitcnt lgkmcnt(10)
  v_mfma_f32_16x16x32_bf16 v[160:163], a[164:167], a[8:11], v[160:163]
  ds_read_b64_tr_b16 a[188:189], v198 offset:24
  v_mfma_f32_16x16x32_bf16 v[164:167], a[164:167], a[12:15], v[164:167]
  ds_read_b64_tr_b16 a[190:191], v198 offset:664
  s_waitcnt lgkmcnt(10)
  v_mfma_f32_16x16x32_bf16 v[168:171], a[168:171], a[8:11], v[168:171]
  ds_read_b64_tr_b16 a[160:161], v198 offset:32
  v_mfma_f32_16x16x32_bf16 v[172:175], a[168:171], a[12:15], v[172:175]
  ds_read_b64_tr_b16 a[162:163], v198 offset:672
  buffer_load_dwordx4 a[48:51], v46, s[8:11], s62 offen offset:0 sc1
  s_waitcnt lgkmcnt(10)
  v_mfma_f32_16x16x32_bf16 v[176:179], a[172:175], a[8:11], v[176:179]
  ds_read_b64_tr_b16 a[164:165], v198 offset:1280
  v_mfma_f32_16x16x32_bf16 v[180:183], a[172:175], a[12:15], v[180:183]
  ds_read_b64_tr_b16 a[166:167], v198 offset:1920
  s_waitcnt vmcnt(8) lgkmcnt(10)
  v_mfma_f32_16x16x32_bf16 v[144:147], a[176:179], a[16:19], v[144:147]
  ds_read_b64_tr_b16 a[168:169], v198 offset:1288
  s_waitcnt vmcnt(7)
  v_mfma_f32_16x16x32_bf16 v[148:151], a[176:179], a[20:23], v[148:151]
  ds_read_b64_tr_b16 a[170:171], v198 offset:1928
  buffer_load_dwordx4 a[52:55], v46, s[8:11], s62 offen offset:2560 sc1
  s_waitcnt lgkmcnt(10)
  v_mfma_f32_16x16x32_bf16 v[152:155], a[180:183], a[16:19], v[152:155]
  ds_read_b64_tr_b16 a[172:173], v198 offset:1296
  v_mfma_f32_16x16x32_bf16 v[156:159], a[180:183], a[20:23], v[156:159]
  ds_read_b64_tr_b16 a[174:175], v198 offset:1936
  s_waitcnt lgkmcnt(10)
  v_mfma_f32_16x16x32_bf16 v[160:163], a[184:187], a[16:19], v[160:163]
  ds_read_b64_tr_b16 a[176:177], v198 offset:1304
  v_mfma_f32_16x16x32_bf16 v[164:167], a[184:187], a[20:23], v[164:167]
  ds_read_b64_tr_b16 a[178:179], v198 offset:1944
  buffer_load_dwordx4 a[56:59], v253, s[8:11], s62 offen offset:0 sc1
  s_waitcnt lgkmcnt(10)
  v_mfma_f32_16x16x32_bf16 v[168:171], a[188:191], a[16:19], v[168:171]
  ds_read_b64_tr_b16 a[180:181], v198 offset:1312
  v_mfma_f32_16x16x32_bf16 v[172:175], a[188:191], a[20:23], v[172:175]
  ds_read_b64_tr_b16 a[182:183], v198 offset:1952
  s_waitcnt lgkmcnt(10)
  v_mfma_f32_16x16x32_bf16 v[176:179], a[160:163], a[16:19], v[176:179]
  ds_read_b64_tr_b16 a[184:185], v199 offset:0
  v_mfma_f32_16x16x32_bf16 v[180:183], a[160:163], a[20:23], v[180:183]
  ds_read_b64_tr_b16 a[186:187], v199 offset:640
  buffer_load_dwordx4 a[60:63], v253, s[8:11], s62 offen offset:2560 sc1
  s_waitcnt vmcnt(9) lgkmcnt(10)
  v_mfma_f32_16x16x32_bf16 v[144:147], a[164:167], a[24:27], v[144:147]
  ds_read_b64_tr_b16 a[188:189], v199 offset:8
  s_waitcnt vmcnt(8)
  v_mfma_f32_16x16x32_bf16 v[148:151], a[164:167], a[28:31], v[148:151]
  ds_read_b64_tr_b16 a[190:191], v199 offset:648
  s_waitcnt lgkmcnt(10)
  v_mfma_f32_16x16x32_bf16 v[152:155], a[168:171], a[24:27], v[152:155]
  ds_read_b64_tr_b16 a[160:161], v199 offset:16
  v_mfma_f32_16x16x32_bf16 v[156:159], a[168:171], a[28:31], v[156:159]
  ds_read_b64_tr_b16 a[162:163], v199 offset:656
  buffer_load_dwordx4 a[64:67], v46, s[8:11], s63 offen offset:0 sc1
  s_waitcnt lgkmcnt(10)
  v_mfma_f32_16x16x32_bf16 v[160:163], a[172:175], a[24:27], v[160:163]
  ds_read_b64_tr_b16 a[164:165], v199 offset:24
  v_mfma_f32_16x16x32_bf16 v[164:167], a[172:175], a[28:31], v[164:167]
  ds_read_b64_tr_b16 a[166:167], v199 offset:664
  s_waitcnt lgkmcnt(10)
  v_mfma_f32_16x16x32_bf16 v[168:171], a[176:179], a[24:27], v[168:171]
  ds_read_b64_tr_b16 a[168:169], v199 offset:32
  v_mfma_f32_16x16x32_bf16 v[172:175], a[176:179], a[28:31], v[172:175]
  ds_read_b64_tr_b16 a[170:171], v199 offset:672
  buffer_load_dwordx4 a[68:71], v46, s[8:11], s63 offen offset:2560 sc1
  s_waitcnt lgkmcnt(10)
  v_mfma_f32_16x16x32_bf16 v[176:179], a[180:183], a[24:27], v[176:179]
  ds_read_b64_tr_b16 a[172:173], v199 offset:1280
  v_mfma_f32_16x16x32_bf16 v[180:183], a[180:183], a[28:31], v[180:183]
  ds_read_b64_tr_b16 a[174:175], v199 offset:1920
  s_waitcnt vmcnt(9) lgkmcnt(10)
  v_mfma_f32_16x16x32_bf16 v[144:147], a[184:187], a[32:35], v[144:147]
  ds_read_b64_tr_b16 a[176:177], v199 offset:1288
  s_waitcnt vmcnt(8)
  v_mfma_f32_16x16x32_bf16 v[148:151], a[184:187], a[36:39], v[148:151]
  ds_read_b64_tr_b16 a[178:179], v199 offset:1928
  buffer_load_dwordx4 a[72:75], v253, s[8:11], s63 offen offset:0 sc1
  s_waitcnt lgkmcnt(10)
  v_mfma_f32_16x16x32_bf16 v[152:155], a[188:191], a[32:35], v[152:155]
  ds_read_b64_tr_b16 a[180:181], v199 offset:1296
  v_mfma_f32_16x16x32_bf16 v[156:159], a[188:191], a[36:39], v[156:159]
  ds_read_b64_tr_b16 a[182:183], v199 offset:1936
  s_waitcnt lgkmcnt(10)
  v_mfma_f32_16x16x32_bf16 v[160:163], a[160:163], a[32:35], v[160:163]
  ds_read_b64_tr_b16 a[184:185], v199 offset:1304
  v_mfma_f32_16x16x32_bf16 v[164:167], a[160:163], a[36:39], v[164:167]
  ds_read_b64_tr_b16 a[186:187], v199 offset:1944
  buffer_load_dwordx4 a[76:79], v253, s[8:11], s63 offen offset:2560 sc1
  s_waitcnt lgkmcnt(10)
  v_mfma_f32_16x16x32_bf16 v[168:171], a[164:167], a[32:35], v[168:171]
  ds_read_b64_tr_b16 a[188:189], v199 offset:1312
  v_mfma_f32_16x16x32_bf16 v[172:175], a[164:167], a[36:39], v[172:175]
  ds_read_b64_tr_b16 a[190:191], v199 offset:1952
  s_waitcnt lgkmcnt(10)
  v_mfma_f32_16x16x32_bf16 v[176:179], a[168:171], a[32:35], v[176:179]
  ds_read_b64_tr_b16 a[160:161], v200 offset:0
  v_mfma_f32_16x16x32_bf16 v[180:183], a[168:171], a[36:39], v[180:183]
  ds_read_b64_tr_b16 a[162:163], v200 offset:640
  buffer_load_dwordx4 a[80:83], v46, s[8:11], s64 offen offset:0 sc1
  s_waitcnt vmcnt(10) lgkmcnt(10)
  v_mfma_f32_16x16x32_bf16 v[144:147], a[172:175], a[40:43], v[144:147]
  ds_read_b64_tr_b16 a[164:165], v200 offset:8
  s_waitcnt vmcnt(9)
  v_mfma_f32_16x16x32_bf16 v[148:151], a[172:175], a[44:47], v[148:151]
  ds_read_b64_tr_b16 a[166:167], v200 offset:648
  s_waitcnt lgkmcnt(10)
  v_mfma_f32_16x16x32_bf16 v[152:155], a[176:179], a[40:43], v[152:155]
  ds_read_b64_tr_b16 a[168:169], v200 offset:16
  v_mfma_f32_16x16x32_bf16 v[156:159], a[176:179], a[44:47], v[156:159]
  ds_read_b64_tr_b16 a[170:171], v200 offset:656
  buffer_load_dwordx4 a[84:87], v46, s[8:11], s64 offen offset:2560 sc1
  s_waitcnt lgkmcnt(10)
  v_mfma_f32_16x16x32_bf16 v[160:163], a[180:183], a[40:43], v[160:163]
  ds_read_b64_tr_b16 a[172:173], v200 offset:24
  v_mfma_f32_16x16x32_bf16 v[164:167], a[180:183], a[44:47], v[164:167]
  ds_read_b64_tr_b16 a[174:175], v200 offset:664
  s_waitcnt lgkmcnt(10)
  v_mfma_f32_16x16x32_bf16 v[168:171], a[184:187], a[40:43], v[168:171]
  ds_read_b64_tr_b16 a[176:177], v200 offset:32
  v_mfma_f32_16x16x32_bf16 v[172:175], a[184:187], a[44:47], v[172:175]
  ds_read_b64_tr_b16 a[178:179], v200 offset:672
  buffer_load_dwordx4 a[88:91], v253, s[8:11], s64 offen offset:0 sc1
  s_waitcnt lgkmcnt(10)
  v_mfma_f32_16x16x32_bf16 v[176:179], a[188:191], a[40:43], v[176:179]
  ds_read_b64_tr_b16 a[180:181], v200 offset:1280
  v_mfma_f32_16x16x32_bf16 v[180:183], a[188:191], a[44:47], v[180:183]
  ds_read_b64_tr_b16 a[182:183], v200 offset:1920
  s_waitcnt vmcnt(10) lgkmcnt(10)
  v_mfma_f32_16x16x32_bf16 v[144:147], a[160:163], a[48:51], v[144:147]
  ds_read_b64_tr_b16 a[184:185], v200 offset:1288
  s_waitcnt vmcnt(9)
  v_mfma_f32_16x16x32_bf16 v[148:151], a[160:163], a[52:55], v[148:151]
  ds_read_b64_tr_b16 a[186:187], v200 offset:1928
  buffer_load_dwordx4 a[92:95], v253, s[8:11], s64 offen offset:2560 sc1
  s_waitcnt lgkmcnt(10)
  v_mfma_f32_16x16x32_bf16 v[152:155], a[164:167], a[48:51], v[152:155]
  ds_read_b64_tr_b16 a[188:189], v200 offset:1296
  v_mfma_f32_16x16x32_bf16 v[156:159], a[164:167], a[52:55], v[156:159]
  ds_read_b64_tr_b16 a[190:191], v200 offset:1936
  s_waitcnt lgkmcnt(10)
  v_mfma_f32_16x16x32_bf16 v[160:163], a[168:171], a[48:51], v[160:163]
  ds_read_b64_tr_b16 a[160:161], v200 offset:1304
  v_mfma_f32_16x16x32_bf16 v[164:167], a[168:171], a[52:55], v[164:167]
  ds_read_b64_tr_b16 a[162:163], v200 offset:1944
  buffer_load_dwordx4 a[96:99], v46, s[8:11], s65 offen offset:0 sc1
  s_waitcnt lgkmcnt(10)
  v_mfma_f32_16x16x32_bf16 v[168:171], a[172:175], a[48:51], v[168:171]
  ds_read_b64_tr_b16 a[164:165], v200 offset:1312
  v_mfma_f32_16x16x32_bf16 v[172:175], a[172:175], a[52:55], v[172:175]
  ds_read_b64_tr_b16 a[166:167], v200 offset:1952
  s_waitcnt lgkmcnt(10)
  v_mfma_f32_16x16x32_bf16 v[176:179], a[176:179], a[48:51], v[176:179]
  ds_read_b64_tr_b16 a[168:169], v201 offset:0
  v_mfma_f32_16x16x32_bf16 v[180:183], a[176:179], a[52:55], v[180:183]
  ds_read_b64_tr_b16 a[170:171], v201 offset:640
  buffer_load_dwordx4 a[100:103], v46, s[8:11], s65 offen offset:2560 sc1
  s_waitcnt vmcnt(11) lgkmcnt(10)
  v_mfma_f32_16x16x32_bf16 v[144:147], a[180:183], a[56:59], v[144:147]
  ds_read_b64_tr_b16 a[172:173], v201 offset:8
  s_waitcnt vmcnt(10)
  v_mfma_f32_16x16x32_bf16 v[148:151], a[180:183], a[60:63], v[148:151]
  ds_read_b64_tr_b16 a[174:175], v201 offset:648
  s_waitcnt lgkmcnt(10)
  v_mfma_f32_16x16x32_bf16 v[152:155], a[184:187], a[56:59], v[152:155]
  ds_read_b64_tr_b16 a[176:177], v201 offset:16
  v_mfma_f32_16x16x32_bf16 v[156:159], a[184:187], a[60:63], v[156:159]
  ds_read_b64_tr_b16 a[178:179], v201 offset:656
  buffer_load_dwordx4 a[104:107], v253, s[8:11], s65 offen offset:0 sc1
  s_waitcnt lgkmcnt(10)
  v_mfma_f32_16x16x32_bf16 v[160:163], a[188:191], a[56:59], v[160:163]
  ds_read_b64_tr_b16 a[180:181], v201 offset:24
  v_mfma_f32_16x16x32_bf16 v[164:167], a[188:191], a[60:63], v[164:167]
  ds_read_b64_tr_b16 a[182:183], v201 offset:664
  s_waitcnt lgkmcnt(10)
  v_mfma_f32_16x16x32_bf16 v[168:171], a[160:163], a[56:59], v[168:171]
  ds_read_b64_tr_b16 a[184:185], v201 offset:32
  v_mfma_f32_16x16x32_bf16 v[172:175], a[160:163], a[60:63], v[172:175]
  ds_read_b64_tr_b16 a[186:187], v201 offset:672
  buffer_load_dwordx4 a[108:111], v253, s[8:11], s65 offen offset:2560 sc1
  s_waitcnt lgkmcnt(10)
  v_mfma_f32_16x16x32_bf16 v[176:179], a[164:167], a[56:59], v[176:179]
  ds_read_b64_tr_b16 a[188:189], v201 offset:1280
  v_mfma_f32_16x16x32_bf16 v[180:183], a[164:167], a[60:63], v[180:183]
  ds_read_b64_tr_b16 a[190:191], v201 offset:1920
  s_waitcnt vmcnt(11) lgkmcnt(10)
  v_mfma_f32_16x16x32_bf16 v[144:147], a[168:171], a[64:67], v[144:147]
  ds_read_b64_tr_b16 a[160:161], v201 offset:1288
  s_waitcnt vmcnt(10)
  v_mfma_f32_16x16x32_bf16 v[148:151], a[168:171], a[68:71], v[148:151]
  ds_read_b64_tr_b16 a[162:163], v201 offset:1928
  s_mov_b32 s3, s44
  buffer_load_dwordx4 a[112:115], v251, s[8:11], s3 offen sc1
  s_waitcnt lgkmcnt(10)
  v_mfma_f32_16x16x32_bf16 v[152:155], a[172:175], a[64:67], v[152:155]
  ds_read_b64_tr_b16 a[164:165], v201 offset:1296
  v_mfma_f32_16x16x32_bf16 v[156:159], a[172:175], a[68:71], v[156:159]
  ds_read_b64_tr_b16 a[166:167], v201 offset:1936
  s_waitcnt lgkmcnt(10)
  v_mfma_f32_16x16x32_bf16 v[160:163], a[176:179], a[64:67], v[160:163]
  ds_read_b64_tr_b16 a[168:169], v201 offset:1304
  v_mfma_f32_16x16x32_bf16 v[164:167], a[176:179], a[68:71], v[164:167]
  ds_read_b64_tr_b16 a[170:171], v201 offset:1944
  s_add_u32 s3, s3, 10240
  buffer_load_dwordx4 a[116:119], v251, s[8:11], s3 offen sc1
  s_waitcnt lgkmcnt(10)
  v_mfma_f32_16x16x32_bf16 v[168:171], a[180:183], a[64:67], v[168:171]
  ds_read_b64_tr_b16 a[172:173], v201 offset:1312
  v_mfma_f32_16x16x32_bf16 v[172:175], a[180:183], a[68:71], v[172:175]
  ds_read_b64_tr_b16 a[174:175], v201 offset:1952
  s_waitcnt lgkmcnt(10)
  v_mfma_f32_16x16x32_bf16 v[176:179], a[184:187], a[64:67], v[176:179]
  ds_read_b64_tr_b16 a[176:177], v202 offset:0
  v_mfma_f32_16x16x32_bf16 v[180:183], a[184:187], a[68:71], v[180:183]
  ds_read_b64_tr_b16 a[178:179], v202 offset:640
  s_add_u32 s3, s3, 10240
  buffer_load_dwordx4 a[120:123], v251, s[8:11], s3 offen sc1
  s_waitcnt vmcnt(12) lgkmcnt(10)
  v_mfma_f32_16x16x32_bf16 v[144:147], a[188:191], a[72:75], v[144:147]
  ds_read_b64_tr_b16 a[180:181], v202 offset:8
  s_waitcnt vmcnt(11)
  v_mfma_f32_16x16x32_bf16 v[148:151], a[188:191], a[76:79], v[148:151]
  ds_read_b64_tr_b16 a[182:183], v202 offset:648
  s_waitcnt lgkmcnt(10)
  v_mfma_f32_16x16x32_bf16 v[152:155], a[160:163], a[72:75], v[152:155]
  ds_read_b64_tr_b16 a[184:185], v202 offset:16
  v_mfma_f32_16x16x32_bf16 v[156:159], a[160:163], a[76:79], v[156:159]
  ds_read_b64_tr_b16 a[186:187], v202 offset:656
  s_add_u32 s3, s3, 10240
  buffer_load_dwordx4 a[124:127], v251, s[8:11], s3 offen sc1
  s_waitcnt lgkmcnt(10)
  v_mfma_f32_16x16x32_bf16 v[160:163], a[164:167], a[72:75], v[160:163]
  ds_read_b64_tr_b16 a[188:189], v202 offset:24
  v_mfma_f32_16x16x32_bf16 v[164:167], a[164:167], a[76:79], v[164:167]
  ds_read_b64_tr_b16 a[190:191], v202 offset:664
  s_waitcnt lgkmcnt(10)
  v_mfma_f32_16x16x32_bf16 v[168:171], a[168:171], a[72:75], v[168:171]
  ds_read_b64_tr_b16 a[160:161], v202 offset:32
  v_mfma_f32_16x16x32_bf16 v[172:175], a[168:171], a[76:79], v[172:175]
  ds_read_b64_tr_b16 a[162:163], v202 offset:672
  s_add_u32 s3, s3, 10240
  buffer_load_dwordx4 a[128:131], v251, s[8:11], s3 offen sc1
  s_waitcnt lgkmcnt(10)
  v_mfma_f32_16x16x32_bf16 v[176:179], a[172:175], a[72:75], v[176:179]
  ds_read_b64_tr_b16 a[164:165], v202 offset:1280
  v_mfma_f32_16x16x32_bf16 v[180:183], a[172:175], a[76:79], v[180:183]
  ds_read_b64_tr_b16 a[166:167], v202 offset:1920
  s_waitcnt vmcnt(12) lgkmcnt(10)
  v_mfma_f32_16x16x32_bf16 v[144:147], a[176:179], a[80:83], v[144:147]
  ds_read_b64_tr_b16 a[168:169], v202 offset:1288
  s_waitcnt vmcnt(11)
  v_mfma_f32_16x16x32_bf16 v[148:151], a[176:179], a[84:87], v[148:151]
  ds_read_b64_tr_b16 a[170:171], v202 offset:1928
  s_add_u32 s3, s3, 10240
  buffer_load_dwordx4 a[132:135], v251, s[8:11], s3 offen sc1
  s_waitcnt lgkmcnt(10)
  v_mfma_f32_16x16x32_bf16 v[152:155], a[180:183], a[80:83], v[152:155]
  ds_read_b64_tr_b16 a[172:173], v202 offset:1296
  v_mfma_f32_16x16x32_bf16 v[156:159], a[180:183], a[84:87], v[156:159]
  ds_read_b64_tr_b16 a[174:175], v202 offset:1936
  s_waitcnt lgkmcnt(10)
  v_mfma_f32_16x16x32_bf16 v[160:163], a[184:187], a[80:83], v[160:163]
  ds_read_b64_tr_b16 a[176:177], v202 offset:1304
  v_mfma_f32_16x16x32_bf16 v[164:167], a[184:187], a[84:87], v[164:167]
  ds_read_b64_tr_b16 a[178:179], v202 offset:1944
  s_add_u32 s3, s3, 10240
  buffer_load_dwordx4 a[136:139], v251, s[8:11], s3 offen sc1
  s_waitcnt lgkmcnt(10)
  v_mfma_f32_16x16x32_bf16 v[168:171], a[188:191], a[80:83], v[168:171]
  ds_read_b64_tr_b16 a[180:181], v202 offset:1312
  v_mfma_f32_16x16x32_bf16 v[172:175], a[188:191], a[84:87], v[172:175]
  ds_read_b64_tr_b16 a[182:183], v202 offset:1952
  s_waitcnt lgkmcnt(10)
  v_mfma_f32_16x16x32_bf16 v[176:179], a[160:163], a[80:83], v[176:179]
  ds_read_b64_tr_b16 a[184:185], v203 offset:0
  v_mfma_f32_16x16x32_bf16 v[180:183], a[160:163], a[84:87], v[180:183]
  ds_read_b64_tr_b16 a[186:187], v203 offset:640
  s_add_u32 s3, s3, 10240
  buffer_load_dwordx4 a[140:143], v251, s[8:11], s3 offen sc1
  s_waitcnt vmcnt(13) lgkmcnt(10)
  v_mfma_f32_16x16x32_bf16 v[144:147], a[164:167], a[88:91], v[144:147]
  ds_read_b64_tr_b16 a[188:189], v203 offset:8
  s_waitcnt vmcnt(12)
  v_mfma_f32_16x16x32_bf16 v[148:151], a[164:167], a[92:95], v[148:151]
  ds_read_b64_tr_b16 a[190:191], v203 offset:648
  s_waitcnt lgkmcnt(10)
  v_mfma_f32_16x16x32_bf16 v[152:155], a[168:171], a[88:91], v[152:155]
  ds_read_b64_tr_b16 a[160:161], v203 offset:16
  v_mfma_f32_16x16x32_bf16 v[156:159], a[168:171], a[92:95], v[156:159]
  ds_read_b64_tr_b16 a[162:163], v203 offset:656
  s_waitcnt lgkmcnt(10)
  v_mfma_f32_16x16x32_bf16 v[160:163], a[172:175], a[88:91], v[160:163]
  ds_read_b64_tr_b16 a[164:165], v203 offset:24
  v_mfma_f32_16x16x32_bf16 v[164:167], a[172:175], a[92:95], v[164:167]
  ds_read_b64_tr_b16 a[166:167], v203 offset:664
  s_waitcnt lgkmcnt(10)
  v_mfma_f32_16x16x32_bf16 v[168:171], a[176:179], a[88:91], v[168:171]
  ds_read_b64_tr_b16 a[168:169], v203 offset:32
  v_mfma_f32_16x16x32_bf16 v[172:175], a[176:179], a[92:95], v[172:175]
  ds_read_b64_tr_b16 a[170:171], v203 offset:672
  s_waitcnt lgkmcnt(10)
  v_mfma_f32_16x16x32_bf16 v[176:179], a[180:183], a[88:91], v[176:179]
  ds_read_b64_tr_b16 a[172:173], v203 offset:1280
  v_mfma_f32_16x16x32_bf16 v[180:183], a[180:183], a[92:95], v[180:183]
  ds_read_b64_tr_b16 a[174:175], v203 offset:1920
  s_waitcnt vmcnt(11) lgkmcnt(10)
  v_mfma_f32_16x16x32_bf16 v[144:147], a[184:187], a[96:99], v[144:147]
  ds_read_b64_tr_b16 a[176:177], v203 offset:1288
  s_waitcnt vmcnt(10)
  v_mfma_f32_16x16x32_bf16 v[148:151], a[184:187], a[100:103], v[148:151]
  ds_read_b64_tr_b16 a[178:179], v203 offset:1928
  s_waitcnt lgkmcnt(10)
  v_mfma_f32_16x16x32_bf16 v[152:155], a[188:191], a[96:99], v[152:155]
  ds_read_b64_tr_b16 a[180:181], v203 offset:1296
  v_mfma_f32_16x16x32_bf16 v[156:159], a[188:191], a[100:103], v[156:159]
  ds_read_b64_tr_b16 a[182:183], v203 offset:1936
  s_waitcnt lgkmcnt(10)
  v_mfma_f32_16x16x32_bf16 v[160:163], a[160:163], a[96:99], v[160:163]
  ds_read_b64_tr_b16 a[184:185], v203 offset:1304
  v_mfma_f32_16x16x32_bf16 v[164:167], a[160:163], a[100:103], v[164:167]
  ds_read_b64_tr_b16 a[186:187], v203 offset:1944
  s_waitcnt lgkmcnt(10)
  v_mfma_f32_16x16x32_bf16 v[168:171], a[164:167], a[96:99], v[168:171]
  ds_read_b64_tr_b16 a[188:189], v203 offset:1312
  v_mfma_f32_16x16x32_bf16 v[172:175], a[164:167], a[100:103], v[172:175]
  ds_read_b64_tr_b16 a[190:191], v203 offset:1952
  s_waitcnt lgkmcnt(10)
  v_mfma_f32_16x16x32_bf16 v[176:179], a[168:171], a[96:99], v[176:179]
  ds_read_b64_tr_b16 a[160:161], v30 offset:2560
  v_mfma_f32_16x16x32_bf16 v[180:183], a[168:171], a[100:103], v[180:183]
  ds_read_b64_tr_b16 a[162:163], v30 offset:8960
  s_waitcnt vmcnt(9) lgkmcnt(10)
  v_mfma_f32_16x16x32_bf16 v[144:147], a[172:175], a[104:107], v[144:147]
  ds_read_b64_tr_b16 a[164:165], v30 offset:2568
  s_waitcnt vmcnt(8)
  v_mfma_f32_16x16x32_bf16 v[148:151], a[172:175], a[108:111], v[148:151]
  ds_read_b64_tr_b16 a[166:167], v30 offset:8968
  s_waitcnt lgkmcnt(10)
  v_mfma_f32_16x16x32_bf16 v[152:155], a[176:179], a[104:107], v[152:155]
  ds_read_b64_tr_b16 a[168:169], v30 offset:2576
  v_mfma_f32_16x16x32_bf16 v[156:159], a[176:179], a[108:111], v[156:159]
  ds_read_b64_tr_b16 a[170:171], v30 offset:8976
  s_waitcnt lgkmcnt(10)
  v_mfma_f32_16x16x32_bf16 v[160:163], a[180:183], a[104:107], v[160:163]
  ds_read_b64_tr_b16 a[172:173], v30 offset:2584
  v_mfma_f32_16x16x32_bf16 v[164:167], a[180:183], a[108:111], v[164:167]
  ds_read_b64_tr_b16 a[174:175], v30 offset:8984
  s_waitcnt lgkmcnt(10)
  v_mfma_f32_16x16x32_bf16 v[168:171], a[184:187], a[104:107], v[168:171]
  ds_read_b64_tr_b16 a[176:177], v30 offset:2592
  v_mfma_f32_16x16x32_bf16 v[172:175], a[184:187], a[108:111], v[172:175]
  ds_read_b64_tr_b16 a[178:179], v30 offset:8992
  s_waitcnt lgkmcnt(10)
  v_mfma_f32_16x16x32_bf16 v[176:179], a[188:191], a[104:107], v[176:179]
  ds_read_b64_tr_b16 a[180:181], v30 offset:28160
  v_mfma_f32_16x16x32_bf16 v[180:183], a[188:191], a[108:111], v[180:183]
  ds_read_b64_tr_b16 a[182:183], v30 offset:34560
  s_waitcnt vmcnt(0)
  s_mov_b64 exec, 1
  buffer_store_dword v6, v51, s[24:27], s5 offen offset:32
  s_mov_b64 exec, -1
  s_waitcnt lgkmcnt(10)
  v_mfma_f32_16x16x32_bf16 v[144:147], a[160:163], a[112:115], v[144:147]
  ds_read_b64_tr_b16 a[184:185], v30 offset:28168
  v_mfma_f32_16x16x32_bf16 v[148:151], a[160:163], a[116:119], v[148:151]
  ds_read_b64_tr_b16 a[186:187], v30 offset:34568
  s_waitcnt lgkmcnt(10)
  v_mfma_f32_16x16x32_bf16 v[152:155], a[164:167], a[112:115], v[152:155]
  ds_read_b64_tr_b16 a[188:189], v30 offset:28176
  v_mfma_f32_16x16x32_bf16 v[156:159], a[164:167], a[116:119], v[156:159]
  ds_read_b64_tr_b16 a[190:191], v30 offset:34576
  s_waitcnt lgkmcnt(10)
  v_mfma_f32_16x16x32_bf16 v[160:163], a[168:171], a[112:115], v[160:163]
  ds_read_b64_tr_b16 a[160:161], v30 offset:28184
  v_mfma_f32_16x16x32_bf16 v[164:167], a[168:171], a[116:119], v[164:167]
  ds_read_b64_tr_b16 a[162:163], v30 offset:34584
  s_waitcnt lgkmcnt(10)
  v_mfma_f32_16x16x32_bf16 v[168:171], a[172:175], a[112:115], v[168:171]
  ds_read_b64_tr_b16 a[164:165], v30 offset:28192
  v_mfma_f32_16x16x32_bf16 v[172:175], a[172:175], a[116:119], v[172:175]
  ds_read_b64_tr_b16 a[166:167], v30 offset:34592
  s_waitcnt lgkmcnt(10)
  v_mfma_f32_16x16x32_bf16 v[176:179], a[176:179], a[112:115], v[176:179]
  ds_read_b64_tr_b16 a[168:169], v31 offset:2560
  v_mfma_f32_16x16x32_bf16 v[180:183], a[176:179], a[116:119], v[180:183]
  ds_read_b64_tr_b16 a[170:171], v31 offset:8960
  s_waitcnt lgkmcnt(10)
  v_mfma_f32_16x16x32_bf16 v[144:147], a[180:183], a[120:123], v[144:147]
  ds_read_b64_tr_b16 a[172:173], v31 offset:2568
  v_mfma_f32_16x16x32_bf16 v[148:151], a[180:183], a[124:127], v[148:151]
  ds_read_b64_tr_b16 a[174:175], v31 offset:8968
  s_waitcnt lgkmcnt(10)
  v_mfma_f32_16x16x32_bf16 v[152:155], a[184:187], a[120:123], v[152:155]
  ds_read_b64_tr_b16 a[176:177], v31 offset:2576
  v_mfma_f32_16x16x32_bf16 v[156:159], a[184:187], a[124:127], v[156:159]
  ds_read_b64_tr_b16 a[178:179], v31 offset:8976
  s_waitcnt lgkmcnt(10)
  v_mfma_f32_16x16x32_bf16 v[160:163], a[188:191], a[120:123], v[160:163]
  ds_read_b64_tr_b16 a[180:181], v31 offset:2584
  v_mfma_f32_16x16x32_bf16 v[164:167], a[188:191], a[124:127], v[164:167]
  ds_read_b64_tr_b16 a[182:183], v31 offset:8984
  s_waitcnt lgkmcnt(10)
  v_mfma_f32_16x16x32_bf16 v[168:171], a[160:163], a[120:123], v[168:171]
  ds_read_b64_tr_b16 a[184:185], v31 offset:2592
  v_mfma_f32_16x16x32_bf16 v[172:175], a[160:163], a[124:127], v[172:175]
  ds_read_b64_tr_b16 a[186:187], v31 offset:8992
  s_waitcnt lgkmcnt(10)
  v_mfma_f32_16x16x32_bf16 v[176:179], a[164:167], a[120:123], v[176:179]
  ds_read_b64_tr_b16 a[188:189], v31 offset:28160
  v_mfma_f32_16x16x32_bf16 v[180:183], a[164:167], a[124:127], v[180:183]
  ds_read_b64_tr_b16 a[190:191], v31 offset:34560
  s_waitcnt lgkmcnt(10)
  v_mfma_f32_16x16x32_bf16 v[144:147], a[168:171], a[128:131], v[144:147]
  ds_read_b64_tr_b16 a[160:161], v31 offset:28168
  v_mfma_f32_16x16x32_bf16 v[148:151], a[168:171], a[132:135], v[148:151]
  ds_read_b64_tr_b16 a[162:163], v31 offset:34568
  s_waitcnt lgkmcnt(10)
  v_mfma_f32_16x16x32_bf16 v[152:155], a[172:175], a[128:131], v[152:155]
  ds_read_b64_tr_b16 a[164:165], v31 offset:28176
  v_mfma_f32_16x16x32_bf16 v[156:159], a[172:175], a[132:135], v[156:159]
  ds_read_b64_tr_b16 a[166:167], v31 offset:34576
  s_waitcnt lgkmcnt(10)
  v_mfma_f32_16x16x32_bf16 v[160:163], a[176:179], a[128:131], v[160:163]
  ds_read_b64_tr_b16 a[168:169], v31 offset:28184
  v_mfma_f32_16x16x32_bf16 v[164:167], a[176:179], a[132:135], v[164:167]
  ds_read_b64_tr_b16 a[170:171], v31 offset:34584
  s_waitcnt lgkmcnt(10)
  v_mfma_f32_16x16x32_bf16 v[168:171], a[180:183], a[128:131], v[168:171]
  ds_read_b64_tr_b16 a[172:173], v31 offset:28192
  v_mfma_f32_16x16x32_bf16 v[172:175], a[180:183], a[132:135], v[172:175]
  ds_read_b64_tr_b16 a[174:175], v31 offset:34592
  s_waitcnt lgkmcnt(10)
  v_mfma_f32_16x16x32_bf16 v[176:179], a[184:187], a[128:131], v[176:179]
  v_mfma_f32_16x16x32_bf16 v[180:183], a[184:187], a[132:135], v[180:183]
  buffer_load_dword v36, v7, s[24:27], s49 offen offset:32 sc1
  s_waitcnt lgkmcnt(8)
  v_mfma_f32_16x16x32_bf16 v[144:147], a[188:191], a[136:139], v[144:147]
  v_mfma_f32_16x16x32_bf16 v[148:151], a[188:191], a[140:143], v[148:151]
  s_waitcnt lgkmcnt(6)
  v_mfma_f32_16x16x32_bf16 v[152:155], a[160:163], a[136:139], v[152:155]
  v_mfma_f32_16x16x32_bf16 v[156:159], a[160:163], a[140:143], v[156:159]
  s_waitcnt lgkmcnt(4)
  v_mfma_f32_16x16x32_bf16 v[160:163], a[164:167], a[136:139], v[160:163]
  v_mfma_f32_16x16x32_bf16 v[164:167], a[164:167], a[140:143], v[164:167]
  s_waitcnt lgkmcnt(2)
  v_mfma_f32_16x16x32_bf16 v[168:171], a[168:171], a[136:139], v[168:171]
  v_mfma_f32_16x16x32_bf16 v[172:175], a[168:171], a[140:143], v[172:175]
  s_waitcnt lgkmcnt(0)
  v_mfma_f32_16x16x32_bf16 v[176:179], a[172:175], a[136:139], v[176:179]
  v_mfma_f32_16x16x32_bf16 v[180:183], a[172:175], a[140:143], v[180:183]
  s_mul_i32 s3, s48, 2560
  s_mul_i32 s4, s28, 1280
  s_add_u32 s3, s3, s4
  s_mul_i32 s4, s30, 160
  s_add_u32 s3, s3, s4
  v_cvt_pk_bf16_f32 v112, v144, v145
  v_cvt_pk_bf16_f32 v113, v146, v147
  ds_write_b64 v194, v[112:113] offset:0
  v_cvt_pk_bf16_f32 v114, v152, v153
  v_cvt_pk_bf16_f32 v115, v154, v155
  ds_write_b64 v194, v[114:115] offset:8
  v_cvt_pk_bf16_f32 v116, v160, v161
  v_cvt_pk_bf16_f32 v117, v162, v163
  ds_write_b64 v194, v[116:117] offset:16
  v_cvt_pk_bf16_f32 v118, v168, v169
  v_cvt_pk_bf16_f32 v119, v170, v171
  ds_write_b64 v194, v[118:119] offset:24
  v_cvt_pk_bf16_f32 v120, v176, v177
  v_cvt_pk_bf16_f32 v121, v178, v179
  ds_write_b64 v194, v[120:121] offset:32
  ds_read_b128 v[64:67], v184 offset:0
  ds_read_b128 v[68:71], v185 offset:1024
  v_cvt_pk_bf16_f32 v122, v148, v149
  v_cvt_pk_bf16_f32 v123, v150, v151
  ds_write_b64 v194, v[122:123] offset:2816
  v_cvt_pk_bf16_f32 v124, v156, v157
  v_cvt_pk_bf16_f32 v125, v158, v159
  ds_write_b64 v194, v[124:125] offset:2824
  v_cvt_pk_bf16_f32 v126, v164, v165
  v_cvt_pk_bf16_f32 v127, v166, v167
  ds_write_b64 v194, v[126:127] offset:2832
  v_cvt_pk_bf16_f32 v128, v172, v173
  v_cvt_pk_bf16_f32 v129, v174, v175
  ds_write_b64 v194, v[128:129] offset:2840
  v_cvt_pk_bf16_f32 v130, v180, v181
  v_cvt_pk_bf16_f32 v131, v182, v183
  ds_write_b64 v194, v[130:131] offset:2848
  ds_read_b128 v[72:75], v186 offset:2048
  ds_read_b128 v[76:79], v187 offset:3072
  ds_read_b128 v[80:83], v188 offset:4096
  s_waitcnt vmcnt(0)
  v_cmp_eq_u32 vcc, s39, v36
  s_nop 0
  s_cmp_eq_u64 vcc, -1
  s_cselect_b32 s4, 0, s80
  s_cmp_eq_u32 s4, 0
  s_nop 0
  s_cbranch_scc1 L_rdok
  s_mov_b32 s46, 16384
L_spin5:
  buffer_load_dword v36, v7, s[24:27], s49 offen offset:32 sc1
  s_waitcnt vmcnt(0)
  v_cmp_eq_u32 vcc, s39, v36
  s_nop 0
  s_cmp_eq_u64 vcc, -1
  s_nop 2
  s_cbranch_scc1 L_spun5
  s_sleep 1
  s_sub_u32 s46, s46, 1
  s_cmp_lg_u32 s46, 0
  s_cbranch_scc1 L_spin5
L_spun5:
L_rdok:
  s_waitcnt lgkmcnt(9)
  buffer_store_dwordx4 v[64:67], v189, s[20:23], s3 offen offset:0
  s_waitcnt lgkmcnt(8)
  buffer_store_dwordx4 v[68:71], v190, s[20:23], s3 offen offset:1024
  s_waitcnt lgkmcnt(2)
  buffer_store_dwordx4 v[72:75], v191, s[20:23], s3 offen offset:2048
  s_waitcnt lgkmcnt(1)
  buffer_store_dwordx4 v[76:79], v192, s[20:23], s3 offen offset:3072
  s_waitcnt lgkmcnt(0)
  buffer_store_dwordx4 v[80:83], v193, s[20:23], s3 offen offset:0
  s_nop 1
L_end:
  s_endpgm
.section .rodata,"a"
.p2align 6
.amdhsa_kernel concat_heads__sliding_local_dilated__linear_attn_block__prompt_kernel
  .amdhsa_next_free_vgpr 512
  .amdhsa_next_free_sgpr 102
  .amdhsa_accum_offset 256
  .amdhsa_group_segment_fixed_size 0
  .amdhsa_kernarg_size 72
  .amdhsa_user_sgpr_count 2
  .amdhsa_user_sgpr_kernarg_segment_ptr 1
  .amdhsa_system_sgpr_workgroup_id_x 1
.end_amdhsa_kernel
```
